```python
import torch

def _softmax(x, axis=-1):
    return torch.softmax(x, dim=axis)
def _gelu(x):
    return torch.nn.functional.gelu(x, approximate="tanh")
def _silu(x):
    return torch.nn.functional.silu(x)
def _sigmoid(x):
    return torch.sigmoid(x)
def _layernorm(x, axis=-1, eps=1e-5):
    m = x.mean(dim=axis, keepdim=True)
    v = x.var(dim=axis, keepdim=True, unbiased=False)
    return (x - m) / torch.sqrt(v + eps)
def _scatter_add(tgt, idx, src, axis=0):
    return tgt.clone().index_add_(axis, idx, src)
def _segment_sum(src, seg, n):
    out = torch.zeros((n,) + src.shape[1:], dtype=src.dtype)
    return out.index_add_(0, seg, src)
def _pad(x, pw):
    flat = tuple(v for pair in reversed(pw) for v in pair)
    return torch.nn.functional.pad(x, flat)

kernel_name = 'sequential_preLN__linear_attn_block__glu_gated_geglu__prompt'

def setup_inputs():

    _w = (lambda a: (lambda t: t.to(torch.bfloat16) if t.is_floating_point() else t)(torch.as_tensor(a)))
    def _A_setup():
        B, S, D = 1, 2048, 448
        return {
            "x": _w((lambda *s: torch.randn(*s, dtype=torch.bfloat16) * 0.05)(B, S, D)),
            "wqkv": _w((lambda *s: torch.randn(*s, dtype=torch.bfloat16) * 0.1)(D, 3 * D)),
            "wo": _w((lambda *s: torch.randn(*s, dtype=torch.bfloat16) * 0.05)(D, D)),
        }
    _A_in = _A_setup()

    def _B_setup():
        B, S, Dm, Df = 1, 2048, 448, 1792
        return {
            "x": _w((lambda *s: torch.randn(*s, dtype=torch.bfloat16) * 0.05)(B, S, Dm)),
            "w_gate": _w((lambda *s: torch.randn(*s, dtype=torch.bfloat16) * 0.4)(Dm, Df) * (Dm ** -0.5)),
            "w_up": _w((lambda *s: torch.randn(*s, dtype=torch.bfloat16) * 0.4)(Dm, Df) * (Dm ** -0.5)),
            "w_down": _w((lambda *s: torch.randn(*s, dtype=torch.bfloat16) * 0.4)(Df, Dm) * (Df ** -0.5)),
        }
    _B_in = _B_setup()

    return {
        "A_x": _A_in["x"],
        "A_wqkv": _A_in["wqkv"],
        "A_wo": _A_in["wo"],
        "B_x": _B_in["x"],
        "B_w_gate": _B_in["w_gate"],
        "B_w_up": _B_in["w_up"],
        "B_w_down": _B_in["w_down"],
    }

def reference(A_x, A_wqkv, A_wo, B_x, B_w_gate, B_w_up, B_w_down):
    def _A_ref(x, wqkv, wo):
        B, S, D = x.shape
        H = 16; Dh = D // H
        qkv = (lambda x, *d: x.permute(*d))((x @ wqkv).reshape(B, S, 3, H, Dh), 2, 0, 3, 1, 4)
        q, k, v = qkv[0], qkv[1], qkv[2]
        phi = lambda t: torch.where(t > 0, t + 1, torch.exp(t)) + 1e-6
        pq, pk = phi(q), phi(k)
        kv = torch.einsum("bhsd,bhse->bhde", pk, v)
        z = torch.einsum("bhsd->bhd", pk)
        num = torch.einsum("bhqd,bhde->bhqe", pq, kv)
        den = torch.einsum("bhqd,bhd->bhq", pq, z)[..., None] + 1e-6
        o = num / den
        return (lambda x, *d: x.permute(*d))(o, 0, 2, 1, 3).reshape(B, S, D) @ wo

    def _B_ref(x, w_gate, w_up, w_down):
        g = torch.einsum("bsd,df->bsf", x, w_gate)
        u = torch.einsum("bsd,df->bsf", x, w_up)
        h = _gelu(g) * u
        return torch.einsum("bsf,fd->bsd", h, w_down)

    x = A_x
    h = x + _A_ref(_layernorm(x, axis=-1), A_wqkv, A_wo)
    h2 = h + _B_ref(_layernorm(h, axis=-1), B_w_gate, B_w_up, B_w_down)
    return h2
```

```asm
; @launch grid=(256,1,1) block=(256,1,1) lds=163840
.amdgcn_target "amdgcn-amd-amdhsa--gfx950"
.text
.globl sequential_preLN__linear_attn_block__glu_gated_geglu__prompt_kernel
.p2align 8
.type sequential_preLN__linear_attn_block__glu_gated_geglu__prompt_kernel,@function
sequential_preLN__linear_attn_block__glu_gated_geglu__prompt_kernel:
    s_load_dwordx2 s[8:9], s[0:1], 0
    s_load_dwordx4 s[12:15], s[0:1], 8
    s_load_dwordx2 s[16:17], s[0:1], 72
    s_cmpk_ge_u32 s2, 256
    s_cbranch_scc1 L_end
    s_getpc_b64 s[44:45]
L_pc:
    s_andn2_b32 s61, s2, 7
    v_lshrrev_b32 v4, 5, v0
    v_lshl_or_b32 v4, v4, 8, s61
    v_mov_b32 v5, 0
    v_lshl_add_u64 v[4:5], v[4:5], 4, s[44:45]
    global_load_dword v255, v[4:5], off
    s_lshr_b32 s50, s2, 3
    s_and_b32 s63, s50, 15
    s_min_u32 s64, s63, 8
    s_sub_u32 s63, s63, s64
    s_lshl_b32 s64, s64, 3
    s_load_dwordx2 s[70:71], s[0:1], s64 offset:8
    s_lshl_b32 s63, s63, 21
    s_lshr_b32 s52, s2, 5
    s_and_b32 s62, s50, 3
    s_and_b32 s49, s2, 7
    s_lshl2_add_u32 s51, s49, s62
    s_add_u32 s55, s52, s2
    s_and_b32 s55, s55, 7
    s_min_u32 s55, s55, 6
    s_lshl_b32 s3, s55, 7
    v_lshrrev_b32 v24, 3, v0
    v_and_b32 v25, 7, v0
    v_lshl_add_u32 v210, s51, 6, v24
    v_mul_u32_u24 v210, 56, v210
    v_add_lshl_u32 v210, v210, v25, 4
    v_add_u32 v211, 28672, v210
    s_mov_b32 s10, 1835008
    s_lshl_b32 s11, 1, 17
    s_sub_u32 s47, s2, 224
    s_cbranch_scc0 L_fill
L_filled:
    s_waitcnt lgkmcnt(0)
    buffer_load_dwordx4 v[32:35], v210, s[8:11], s3 offen
    s_load_dword s72, s[70:71], s63
    buffer_load_dwordx4 v[36:39], v211, s[8:11], s3 offen
    s_addk_i32 s3, 128
    s_cmpk_eq_u32 s3, 896
    s_cselect_b32 s3, 0, s3
    s_mov_b64 s[20:21], s[14:15]
    s_mov_b32 s14, 1204224
    s_mov_b32 s15, s11
    s_mov_b32 s22, 401408
    s_mov_b32 s23, s11
    v_lshl_add_u32 v6, s2, 8, v0
    v_mul_u32_u24 v7, 24, v6
    v_lshlrev_b32 v6, 3, v6
    buffer_load_dword v254, v7, s[12:15], 0 offen
    buffer_load_dword v254, v6, s[20:23], 0 offen
    buffer_load_dwordx4 v[40:43], v210, s[8:11], s3 offen
    buffer_load_dwordx4 v[44:47], v211, s[8:11], s3 offen
    s_addk_i32 s3, 128
    s_cmpk_eq_u32 s3, 896
    s_cselect_b32 s3, 0, s3
    buffer_load_dwordx4 v[48:51], v210, s[8:11], s3 offen
    buffer_load_dwordx4 v[52:55], v211, s[8:11], s3 offen
    s_addk_i32 s3, 128
    s_cmpk_eq_u32 s3, 896
    s_cselect_b32 s3, 0, s3
    s_load_dwordx2 s[40:41], s[0:1], 64
    s_load_dwordx2 s[24:25], s[0:1], 32
    s_load_dwordx2 s[28:29], s[0:1], 40
    s_load_dwordx2 s[32:33], s[0:1], 48
    s_load_dwordx2 s[36:37], s[0:1], 56
    v_lshrrev_b32 v6, 6, v0
    s_mov_b32 s18, 16777216
    s_mov_b32 s19, s11
    v_readfirstlane_b32 s48, v6
    s_branch L_nofill
L_fill:
    s_mov_b32 s18, 16777216
    s_mov_b32 s19, s11
    v_mov_b32 v20, -1
    v_mov_b32 v21, -1
    v_mov_b32 v22, -1
    v_mov_b32 v23, -1
    v_lshlrev_b32 v4, 7, v0
    v_min_u32 v4, L_end-L_pc-32768, v4
    v_add_u32 v4, 32768, v4
    v_mov_b32 v5, 0
    v_lshl_add_u64 v[4:5], v[4:5], 0, s[44:45]
    global_load_dword v255, v[4:5], off
    s_mul_i32 s56, s47, 45056
    s_add_u32 s56, s56, 0
    v_lshlrev_b32 v4, 4, v0
    s_waitcnt lgkmcnt(0)
    buffer_store_dwordx4 v[20:23], v4, s[16:19], s56 offen sc1
    s_addk_i32 s56, 4096
    buffer_store_dwordx4 v[20:23], v4, s[16:19], s56 offen sc1
    s_addk_i32 s56, 4096
    buffer_store_dwordx4 v[20:23], v4, s[16:19], s56 offen sc1
    s_addk_i32 s56, 4096
    buffer_store_dwordx4 v[20:23], v4, s[16:19], s56 offen sc1
    s_addk_i32 s56, 4096
    buffer_store_dwordx4 v[20:23], v4, s[16:19], s56 offen sc1
    s_addk_i32 s56, 4096
    buffer_store_dwordx4 v[20:23], v4, s[16:19], s56 offen sc1
    s_addk_i32 s56, 4096
    buffer_store_dwordx4 v[20:23], v4, s[16:19], s56 offen sc1
    s_addk_i32 s56, 4096
    buffer_store_dwordx4 v[20:23], v4, s[16:19], s56 offen sc1
    s_addk_i32 s56, 4096
    buffer_store_dwordx4 v[20:23], v4, s[16:19], s56 offen sc1
    s_addk_i32 s56, 4096
    buffer_store_dwordx4 v[20:23], v4, s[16:19], s56 offen sc1
    s_addk_i32 s56, 4096
    buffer_store_dwordx4 v[20:23], v4, s[16:19], s56 offen sc1
    s_addk_i32 s56, 4096
    s_branch L_filled
L_pub:
    s_barrier
    s_movk_i32 s42, 256
    s_mov_b32 s43, s11
    v_mov_b32 v214, 1
    v_lshlrev_b32 v224, 28, s48
    s_waitcnt lgkmcnt(0)
    s_mov_b64 exec, 1
    buffer_atomic_add v214, v224, s[40:43], 0 offen sc1
    s_mov_b64 exec, -1
    s_branch L_pubd
L_nofill:
    v_mov_b32 v20, 0
    v_mov_b32 v21, 0
    v_mov_b32 v22, 0
    v_mov_b32 v23, 0
    s_mul_i32 s62, s52, 112
    s_min_u32 s58, s62, 768
    s_sub_u32 s62, s62, s58
    s_mul_i32 s67, s55, 172032
    s_add_u32 s55, s67, s58
    s_add_u32 s60, s58, s14
    s_lshl_b32 s6, s48, 12
    v_lshrrev_b32 v4, 2, v0
    v_and_b32 v4, 4, v4
    v_xor_b32 v4, v4, v25
    v_lshl_add_u32 v5, v6, 3, v24
    v_mul_u32_u24 v216, 2688, v5
    v_lshl_add_u32 v216, v4, 4, v216
    v_add_u32 v8, 896, v216
    v_add_u32 v9, 768, v216
    v_add_u32 v10, 20352, v216
    v_add_u32 v11, 20224, v216
    s_mov_b32 s65, 0x3f803f80
    s_mov_b32 s4, 0xffff0000
    v_xor_b32 v4, v24, v25
    v_lshlrev_b32 v4, 4, v4
    v_lshl_add_u32 v212, v25, 9, v4
    v_and_b32 v1, 63, v0
    s_mov_b32 s26, 1605632
    s_mov_b32 s27, s11
    s_mov_b32 s30, s26
    s_mov_b32 s31, s11
    s_mov_b32 s34, s26
    s_mov_b32 s35, s11
    s_mov_b32 s38, s10
    s_mov_b32 s39, s11
    s_movk_i32 s42, 256
    s_mov_b32 s43, s11
    v_lshlrev_b32 v2, 4, v1
    v_lshlrev_b32 v3, 2, v1
    s_lshr_b32 s75, s2, 6
    s_min_u32 s54, s52, 6
    s_lshl_b32 s54, s54, 7
    s_add_u32 s67, s67, s54
    s_add_u32 s81, s54, s14
    s_lshl_b32 s5, s48, 11
    v_add_u32 v217, 19456, v216
    s_lshr_b32 s61, s48, 1
    s_lshl1_add_u32 s53, s52, s61
    s_mul_i32 s63, s61, 56
    s_add_u32 s62, s62, s63
    s_and_b32 s64, s6, 4096
    v_and_b32 v4, 31, v1
    v_lshrrev_b32 v5, 5, v1
    v_xor_b32 v7, v5, v4
    v_lshlrev_b32 v7, 4, v7
    v_lshl_add_u32 v7, v5, 9, v7
    v_add_u32 v12, s64, v7
    v_xor_b32 v13, 1056, v12
    v_xor_b32 v14, 2112, v12
    v_xor_b32 v15, 3168, v12
    v_bfe_u32 v26, v1, 2, 2
    v_lshl_add_u32 v27, v5, 3, v26
    v_lshlrev_b32 v27, 7, v27
    v_lshl_add_u32 v6, v5, 10, v27
    v_add_u32 v6, 65536, v6
    v_bfe_u32 v4, v1, 4, 1
    v_and_b32 v5, 3, v1
    v_lshl_add_u32 v4, v4, 2, v5
    v_lshlrev_b32 v4, 3, v4
    v_bfe_u32 v5, v1, 3, 1
    v_lshl_add_u32 v4, v5, 6, v4
    s_lshl_b32 s61, s61, 6
    v_add_u32 v5, s62, v4
    v_and_b32 v5, 127, v5
    v_add_u32 v218, v5, v6
    v_add_u32 v219, 0x10000, v218
    v_lshrrev_b32 v5, 1, v4
    v_xor_b32 v5, v5, v4
    v_and_b32 v5, 8, v5
    v_mul_u32_u24 v5, 3, v5
    v_xor_b32 v4, v4, v5
    s_lshr_b32 s63, s61, 3
    s_sub_u32 s62, s62, s63
    s_lshr_b32 s63, s64, 7
    v_xor_b32 v5, s63, v4
    v_add_u32 v5, s62, v5
    v_and_b32 v5, 127, v5
    v_add_u32 v16, v5, v6
    v_add_u32 v17, 0x10000, v16
    v_xor_b32 v5, s61, v4
    v_add_u32 v18, v5, v6
    v_add_u32 v19, 0x10000, v18
    v_mov_b32 v28, s65
    s_waitcnt vmcnt(7)
    v_dot2c_f32_bf16 v20, s65, v32
    v_lshlrev_b32 v88, 16, v32
    v_dot2c_f32_bf16 v21, v32, v32
    v_and_b32 v89, s4, v32
    buffer_load_dwordx4 v[56:59], v210, s[8:11], s3 offen
    v_dot2c_f32_bf16 v20, s65, v33
    v_lshlrev_b32 v90, 16, v33
    v_dot2c_f32_bf16 v21, v33, v33
    v_and_b32 v91, s4, v33
    v_dot2c_f32_bf16 v20, s65, v34
    v_lshlrev_b32 v92, 16, v34
    v_dot2c_f32_bf16 v21, v34, v34
    v_and_b32 v93, s4, v34
    buffer_load_dwordx4 v[60:63], v211, s[8:11], s3 offen
    s_addk_i32 s3, 128
    s_cmpk_eq_u32 s3, 896
    s_cselect_b32 s3, 0, s3
    v_dot2c_f32_bf16 v20, s65, v35
    v_lshlrev_b32 v94, 16, v35
    v_dot2c_f32_bf16 v21, v35, v35
    v_and_b32 v95, s4, v35
    s_waitcnt vmcnt(8)
    v_dot2c_f32_bf16 v22, s65, v36
    v_lshlrev_b32 v96, 16, v36
    v_dot2c_f32_bf16 v23, v36, v36
    v_and_b32 v97, s4, v36
    buffer_load_dwordx4 v[64:67], v210, s[8:11], s3 offen
    v_dot2c_f32_bf16 v22, s65, v37
    v_lshlrev_b32 v98, 16, v37
    v_dot2c_f32_bf16 v23, v37, v37
    v_and_b32 v99, s4, v37
    v_dot2c_f32_bf16 v22, s65, v38
    v_lshlrev_b32 v100, 16, v38
    v_dot2c_f32_bf16 v23, v38, v38
    v_and_b32 v101, s4, v38
    buffer_load_dwordx4 v[68:71], v211, s[8:11], s3 offen
    s_addk_i32 s3, 128
    s_cmpk_eq_u32 s3, 896
    s_cselect_b32 s3, 0, s3
    v_dot2c_f32_bf16 v22, s65, v39
    v_lshlrev_b32 v102, 16, v39
    v_dot2c_f32_bf16 v23, v39, v39
    v_and_b32 v103, s4, v39
    s_waitcnt vmcnt(7)
    v_dot2c_f32_bf16 v20, s65, v40
    v_lshlrev_b32 v104, 16, v40
    v_dot2c_f32_bf16 v21, v40, v40
    v_and_b32 v105, s4, v40
    buffer_load_dwordx4 v[72:75], v210, s[8:11], s3 offen
    v_dot2c_f32_bf16 v20, s65, v41
    v_lshlrev_b32 v106, 16, v41
    v_dot2c_f32_bf16 v21, v41, v41
    v_and_b32 v107, s4, v41
    v_dot2c_f32_bf16 v20, s65, v42
    v_lshlrev_b32 v108, 16, v42
    v_dot2c_f32_bf16 v21, v42, v42
    v_and_b32 v109, s4, v42
    buffer_load_dwordx4 v[76:79], v211, s[8:11], s3 offen
    s_addk_i32 s3, 128
    s_cmpk_eq_u32 s3, 896
    s_cselect_b32 s3, 0, s3
    v_dot2c_f32_bf16 v20, s65, v43
    v_lshlrev_b32 v110, 16, v43
    v_dot2c_f32_bf16 v21, v43, v43
    v_and_b32 v111, s4, v43
    s_waitcnt vmcnt(8)
    v_dot2c_f32_bf16 v22, s65, v44
    v_lshlrev_b32 v112, 16, v44
    v_dot2c_f32_bf16 v23, v44, v44
    v_and_b32 v113, s4, v44
    buffer_load_dwordx4 v[80:83], v210, s[8:11], s3 offen
    v_dot2c_f32_bf16 v22, s65, v45
    v_lshlrev_b32 v114, 16, v45
    v_dot2c_f32_bf16 v23, v45, v45
    v_and_b32 v115, s4, v45
    s_cmp_lt_u32 s47, 32
    s_cbranch_scc1 L_pub
L_pubd:
    v_dot2c_f32_bf16 v22, s65, v46
    v_lshlrev_b32 v116, 16, v46
    v_dot2c_f32_bf16 v23, v46, v46
    v_and_b32 v117, s4, v46
    buffer_load_dwordx4 v[84:87], v211, s[8:11], s3 offen
    v_dot2c_f32_bf16 v22, s65, v47
    v_lshlrev_b32 v118, 16, v47
    v_dot2c_f32_bf16 v23, v47, v47
    v_and_b32 v119, s4, v47
    s_waitcnt vmcnt(9)
    v_dot2c_f32_bf16 v20, s65, v48
    v_lshlrev_b32 v120, 16, v48
    v_dot2c_f32_bf16 v21, v48, v48
    v_and_b32 v121, s4, v48
    s_add_u32 m0, s6, 65536
    s_nop 0
    buffer_load_dwordx4 v8, s[12:15], s55 offen offset:0 lds
    v_dot2c_f32_bf16 v20, s65, v49
    v_lshlrev_b32 v122, 16, v49
    v_dot2c_f32_bf16 v21, v49, v49
    v_and_b32 v123, s4, v49
    v_dot2c_f32_bf16 v20, s65, v50
    v_lshlrev_b32 v124, 16, v50
    v_dot2c_f32_bf16 v21, v50, v50
    v_and_b32 v125, s4, v50
    v_dot2c_f32_bf16 v20, s65, v51
    v_lshlrev_b32 v126, 16, v51
    v_dot2c_f32_bf16 v21, v51, v51
    v_and_b32 v127, s4, v51
    s_waitcnt vmcnt(9)
    v_dot2c_f32_bf16 v22, s65, v52
    v_lshlrev_b32 v128, 16, v52
    v_dot2c_f32_bf16 v23, v52, v52
    v_and_b32 v129, s4, v52
    buffer_load_dwordx4 v9, s[12:15], s55 offen offset:1024 lds
    v_dot2c_f32_bf16 v22, s65, v53
    v_lshlrev_b32 v130, 16, v53
    v_dot2c_f32_bf16 v23, v53, v53
    v_and_b32 v131, s4, v53
    v_dot2c_f32_bf16 v22, s65, v54
    v_lshlrev_b32 v132, 16, v54
    v_dot2c_f32_bf16 v23, v54, v54
    v_and_b32 v133, s4, v54
    v_dot2c_f32_bf16 v22, s65, v55
    v_lshlrev_b32 v134, 16, v55
    v_dot2c_f32_bf16 v23, v55, v55
    v_and_b32 v135, s4, v55
    s_waitcnt vmcnt(9)
    v_dot2c_f32_bf16 v20, s65, v56
    v_lshlrev_b32 v136, 16, v56
    v_dot2c_f32_bf16 v21, v56, v56
    v_and_b32 v137, s4, v56
    buffer_load_dwordx4 v10, s[12:15], s55 offen offset:2048 lds
    v_dot2c_f32_bf16 v20, s65, v57
    v_lshlrev_b32 v138, 16, v57
    v_dot2c_f32_bf16 v21, v57, v57
    v_and_b32 v139, s4, v57
    v_dot2c_f32_bf16 v20, s65, v58
    v_lshlrev_b32 v140, 16, v58
    v_dot2c_f32_bf16 v21, v58, v58
    v_and_b32 v141, s4, v58
    v_dot2c_f32_bf16 v20, s65, v59
    v_lshlrev_b32 v142, 16, v59
    v_dot2c_f32_bf16 v21, v59, v59
    v_and_b32 v143, s4, v59
    s_waitcnt vmcnt(9)
    v_dot2c_f32_bf16 v22, s65, v60
    v_lshlrev_b32 v144, 16, v60
    v_dot2c_f32_bf16 v23, v60, v60
    v_and_b32 v145, s4, v60
    buffer_load_dwordx4 v11, s[12:15], s55 offen offset:3072 lds
    s_add_u32 s55, s55, 172032
    s_cmp_eq_u32 s55, s60
    s_cselect_b32 s55, s58, s55
    v_dot2c_f32_bf16 v22, s65, v61
    v_lshlrev_b32 v146, 16, v61
    v_dot2c_f32_bf16 v23, v61, v61
    v_and_b32 v147, s4, v61
    v_dot2c_f32_bf16 v22, s65, v62
    v_lshlrev_b32 v148, 16, v62
    v_dot2c_f32_bf16 v23, v62, v62
    v_and_b32 v149, s4, v62
    v_dot2c_f32_bf16 v22, s65, v63
    v_lshlrev_b32 v150, 16, v63
    v_dot2c_f32_bf16 v23, v63, v63
    v_and_b32 v151, s4, v63
    s_waitcnt vmcnt(9)
    v_dot2c_f32_bf16 v20, s65, v64
    v_lshlrev_b32 v152, 16, v64
    v_dot2c_f32_bf16 v21, v64, v64
    v_and_b32 v153, s4, v64
    v_dot2c_f32_bf16 v20, s65, v65
    v_lshlrev_b32 v154, 16, v65
    v_dot2c_f32_bf16 v21, v65, v65
    v_and_b32 v155, s4, v65
    v_dot2c_f32_bf16 v20, s65, v66
    v_lshlrev_b32 v156, 16, v66
    v_dot2c_f32_bf16 v21, v66, v66
    v_and_b32 v157, s4, v66
    v_dot2c_f32_bf16 v20, s65, v67
    v_lshlrev_b32 v158, 16, v67
    v_dot2c_f32_bf16 v21, v67, v67
    v_and_b32 v159, s4, v67
    s_waitcnt vmcnt(8)
    v_dot2c_f32_bf16 v22, s65, v68
    v_lshlrev_b32 v160, 16, v68
    v_dot2c_f32_bf16 v23, v68, v68
    v_and_b32 v161, s4, v68
    v_dot2c_f32_bf16 v22, s65, v69
    v_lshlrev_b32 v162, 16, v69
    v_dot2c_f32_bf16 v23, v69, v69
    v_and_b32 v163, s4, v69
    v_dot2c_f32_bf16 v22, s65, v70
    v_lshlrev_b32 v164, 16, v70
    v_dot2c_f32_bf16 v23, v70, v70
    v_and_b32 v165, s4, v70
    v_dot2c_f32_bf16 v22, s65, v71
    v_lshlrev_b32 v166, 16, v71
    v_dot2c_f32_bf16 v23, v71, v71
    v_and_b32 v167, s4, v71
    s_waitcnt vmcnt(7)
    v_dot2c_f32_bf16 v20, s65, v72
    v_lshlrev_b32 v168, 16, v72
    v_dot2c_f32_bf16 v21, v72, v72
    v_and_b32 v169, s4, v72
    s_add_u32 m0, s6, 81920
    s_nop 0
    buffer_load_dwordx4 v8, s[12:15], s55 offen offset:0 lds
    v_dot2c_f32_bf16 v20, s65, v73
    v_lshlrev_b32 v170, 16, v73
    v_dot2c_f32_bf16 v21, v73, v73
    v_and_b32 v171, s4, v73
    v_dot2c_f32_bf16 v20, s65, v74
    v_lshlrev_b32 v172, 16, v74
    v_dot2c_f32_bf16 v21, v74, v74
    v_and_b32 v173, s4, v74
    v_dot2c_f32_bf16 v20, s65, v75
    v_lshlrev_b32 v174, 16, v75
    v_dot2c_f32_bf16 v21, v75, v75
    v_and_b32 v175, s4, v75
    s_waitcnt vmcnt(7)
    v_dot2c_f32_bf16 v22, s65, v76
    v_lshlrev_b32 v176, 16, v76
    v_dot2c_f32_bf16 v23, v76, v76
    v_and_b32 v177, s4, v76
    buffer_load_dwordx4 v9, s[12:15], s55 offen offset:1024 lds
    v_dot2c_f32_bf16 v22, s65, v77
    v_lshlrev_b32 v178, 16, v77
    v_dot2c_f32_bf16 v23, v77, v77
    v_and_b32 v179, s4, v77
    v_dot2c_f32_bf16 v22, s65, v78
    v_lshlrev_b32 v180, 16, v78
    v_dot2c_f32_bf16 v23, v78, v78
    v_and_b32 v181, s4, v78
    v_dot2c_f32_bf16 v22, s65, v79
    v_lshlrev_b32 v182, 16, v79
    v_dot2c_f32_bf16 v23, v79, v79
    v_and_b32 v183, s4, v79
    s_waitcnt vmcnt(7)
    v_dot2c_f32_bf16 v20, s65, v80
    v_lshlrev_b32 v184, 16, v80
    v_dot2c_f32_bf16 v21, v80, v80
    v_and_b32 v185, s4, v80
    buffer_load_dwordx4 v10, s[12:15], s55 offen offset:2048 lds
    v_dot2c_f32_bf16 v20, s65, v81
    v_lshlrev_b32 v186, 16, v81
    v_dot2c_f32_bf16 v21, v81, v81
    v_and_b32 v187, s4, v81
    v_dot2c_f32_bf16 v20, s65, v82
    v_lshlrev_b32 v188, 16, v82
    v_dot2c_f32_bf16 v21, v82, v82
    v_and_b32 v189, s4, v82
    v_dot2c_f32_bf16 v20, s65, v83
    v_lshlrev_b32 v190, 16, v83
    v_dot2c_f32_bf16 v21, v83, v83
    v_and_b32 v191, s4, v83
    s_waitcnt vmcnt(7)
    v_dot2c_f32_bf16 v22, s65, v84
    v_lshlrev_b32 v192, 16, v84
    v_dot2c_f32_bf16 v23, v84, v84
    v_and_b32 v193, s4, v84
    buffer_load_dwordx4 v11, s[12:15], s55 offen offset:3072 lds
    s_add_u32 s55, s55, 172032
    s_cmp_eq_u32 s55, s60
    s_cselect_b32 s55, s58, s55
    v_dot2c_f32_bf16 v22, s65, v85
    v_lshlrev_b32 v194, 16, v85
    v_dot2c_f32_bf16 v23, v85, v85
    v_and_b32 v195, s4, v85
    v_dot2c_f32_bf16 v22, s65, v86
    v_lshlrev_b32 v196, 16, v86
    v_dot2c_f32_bf16 v23, v86, v86
    v_and_b32 v197, s4, v86
    v_dot2c_f32_bf16 v22, s65, v87
    v_lshlrev_b32 v198, 16, v87
    v_dot2c_f32_bf16 v23, v87, v87
    v_and_b32 v199, s4, v87
    v_add_f32_dpp v20, v20, v20 quad_perm:[1,0,3,2] row_mask:0xf bank_mask:0xf
    v_add_f32_dpp v21, v21, v21 quad_perm:[1,0,3,2] row_mask:0xf bank_mask:0xf
    v_add_f32_dpp v22, v22, v22 quad_perm:[1,0,3,2] row_mask:0xf bank_mask:0xf
    v_add_f32_dpp v23, v23, v23 quad_perm:[1,0,3,2] row_mask:0xf bank_mask:0xf
    v_add_f32_dpp v20, v20, v20 quad_perm:[2,3,0,1] row_mask:0xf bank_mask:0xf
    v_add_f32_dpp v21, v21, v21 quad_perm:[2,3,0,1] row_mask:0xf bank_mask:0xf
    v_add_f32_dpp v22, v22, v22 quad_perm:[2,3,0,1] row_mask:0xf bank_mask:0xf
    v_add_f32_dpp v23, v23, v23 quad_perm:[2,3,0,1] row_mask:0xf bank_mask:0xf
    v_add_f32_dpp v20, v20, v20 row_half_mirror row_mask:0xf bank_mask:0xf
    v_add_f32_dpp v21, v21, v21 row_half_mirror row_mask:0xf bank_mask:0xf
    v_add_f32_dpp v22, v22, v22 row_half_mirror row_mask:0xf bank_mask:0xf
    v_add_f32_dpp v23, v23, v23 row_half_mirror row_mask:0xf bank_mask:0xf
    v_mul_f32 v20, 0x3b124925, v20
    v_mul_f32 v22, 0x3b124925, v22
    v_mul_f32 v21, 0x3b124925, v21
    v_mul_f32 v23, 0x3b124925, v23
    v_fma_f32 v21, -v20, v20, v21
    v_fma_f32 v23, -v22, v22, v23
    v_max_f32 v21, 0, v21
    v_max_f32 v23, 0, v23
    v_add_f32 v21, 0x3727c5ac, v21
    v_add_f32 v23, 0x3727c5ac, v23
    v_rsq_f32 v21, v21
    v_rsq_f32 v23, v23
    v_mul_f32 v20, v20, v21
    v_mul_f32 v22, v22, v23
    v_pk_fma_f32 v[88:89], v[88:89], v[20:21], v[20:21] op_sel:[0,1,0] op_sel_hi:[1,1,0] neg_lo:[0,0,1] neg_hi:[0,0,1]
    v_pk_fma_f32 v[90:91], v[90:91], v[20:21], v[20:21] op_sel:[0,1,0] op_sel_hi:[1,1,0] neg_lo:[0,0,1] neg_hi:[0,0,1]
    v_pk_fma_f32 v[92:93], v[92:93], v[20:21], v[20:21] op_sel:[0,1,0] op_sel_hi:[1,1,0] neg_lo:[0,0,1] neg_hi:[0,0,1]
    v_pk_fma_f32 v[94:95], v[94:95], v[20:21], v[20:21] op_sel:[0,1,0] op_sel_hi:[1,1,0] neg_lo:[0,0,1] neg_hi:[0,0,1]
    v_cvt_pk_bf16_f32 v32, v88, v89
    v_cvt_pk_bf16_f32 v33, v90, v91
    v_cvt_pk_bf16_f32 v34, v92, v93
    v_cvt_pk_bf16_f32 v35, v94, v95
    ds_write_b128 v212, v[32:35] offset:0
    v_pk_fma_f32 v[96:97], v[96:97], v[22:23], v[22:23] op_sel:[0,1,0] op_sel_hi:[1,1,0] neg_lo:[0,0,1] neg_hi:[0,0,1]
    v_pk_fma_f32 v[98:99], v[98:99], v[22:23], v[22:23] op_sel:[0,1,0] op_sel_hi:[1,1,0] neg_lo:[0,0,1] neg_hi:[0,0,1]
    v_pk_fma_f32 v[100:101], v[100:101], v[22:23], v[22:23] op_sel:[0,1,0] op_sel_hi:[1,1,0] neg_lo:[0,0,1] neg_hi:[0,0,1]
    s_add_u32 m0, s6, 98304
    s_nop 0
    buffer_load_dwordx4 v8, s[12:15], s55 offen offset:0 lds
    v_pk_fma_f32 v[102:103], v[102:103], v[22:23], v[22:23] op_sel:[0,1,0] op_sel_hi:[1,1,0] neg_lo:[0,0,1] neg_hi:[0,0,1]
    v_cvt_pk_bf16_f32 v36, v96, v97
    v_cvt_pk_bf16_f32 v37, v98, v99
    v_cvt_pk_bf16_f32 v38, v100, v101
    v_cvt_pk_bf16_f32 v39, v102, v103
    ds_write_b128 v212, v[36:39] offset:4096
    v_pk_fma_f32 v[104:105], v[104:105], v[20:21], v[20:21] op_sel:[0,1,0] op_sel_hi:[1,1,0] neg_lo:[0,0,1] neg_hi:[0,0,1]
    v_pk_fma_f32 v[106:107], v[106:107], v[20:21], v[20:21] op_sel:[0,1,0] op_sel_hi:[1,1,0] neg_lo:[0,0,1] neg_hi:[0,0,1]
    v_pk_fma_f32 v[108:109], v[108:109], v[20:21], v[20:21] op_sel:[0,1,0] op_sel_hi:[1,1,0] neg_lo:[0,0,1] neg_hi:[0,0,1]
    buffer_load_dwordx4 v9, s[12:15], s55 offen offset:1024 lds
    v_pk_fma_f32 v[110:111], v[110:111], v[20:21], v[20:21] op_sel:[0,1,0] op_sel_hi:[1,1,0] neg_lo:[0,0,1] neg_hi:[0,0,1]
    v_cvt_pk_bf16_f32 v40, v104, v105
    v_cvt_pk_bf16_f32 v41, v106, v107
    v_cvt_pk_bf16_f32 v42, v108, v109
    v_cvt_pk_bf16_f32 v43, v110, v111
    ds_write_b128 v212, v[40:43] offset:8192
    v_pk_fma_f32 v[112:113], v[112:113], v[22:23], v[22:23] op_sel:[0,1,0] op_sel_hi:[1,1,0] neg_lo:[0,0,1] neg_hi:[0,0,1]
    v_pk_fma_f32 v[114:115], v[114:115], v[22:23], v[22:23] op_sel:[0,1,0] op_sel_hi:[1,1,0] neg_lo:[0,0,1] neg_hi:[0,0,1]
    v_pk_fma_f32 v[116:117], v[116:117], v[22:23], v[22:23] op_sel:[0,1,0] op_sel_hi:[1,1,0] neg_lo:[0,0,1] neg_hi:[0,0,1]
    buffer_load_dwordx4 v10, s[12:15], s55 offen offset:2048 lds
    v_pk_fma_f32 v[118:119], v[118:119], v[22:23], v[22:23] op_sel:[0,1,0] op_sel_hi:[1,1,0] neg_lo:[0,0,1] neg_hi:[0,0,1]
    v_cvt_pk_bf16_f32 v44, v112, v113
    v_cvt_pk_bf16_f32 v45, v114, v115
    v_cvt_pk_bf16_f32 v46, v116, v117
    v_cvt_pk_bf16_f32 v47, v118, v119
    ds_write_b128 v212, v[44:47] offset:12288
    v_pk_fma_f32 v[120:121], v[120:121], v[20:21], v[20:21] op_sel:[0,1,0] op_sel_hi:[1,1,0] neg_lo:[0,0,1] neg_hi:[0,0,1]
    v_pk_fma_f32 v[122:123], v[122:123], v[20:21], v[20:21] op_sel:[0,1,0] op_sel_hi:[1,1,0] neg_lo:[0,0,1] neg_hi:[0,0,1]
    v_pk_fma_f32 v[124:125], v[124:125], v[20:21], v[20:21] op_sel:[0,1,0] op_sel_hi:[1,1,0] neg_lo:[0,0,1] neg_hi:[0,0,1]
    buffer_load_dwordx4 v11, s[12:15], s55 offen offset:3072 lds
    s_add_u32 s55, s55, 172032
    s_cmp_eq_u32 s55, s60
    s_cselect_b32 s55, s58, s55
    v_pk_fma_f32 v[126:127], v[126:127], v[20:21], v[20:21] op_sel:[0,1,0] op_sel_hi:[1,1,0] neg_lo:[0,0,1] neg_hi:[0,0,1]
    v_cvt_pk_bf16_f32 v48, v120, v121
    v_cvt_pk_bf16_f32 v49, v122, v123
    v_cvt_pk_bf16_f32 v50, v124, v125
    v_cvt_pk_bf16_f32 v51, v126, v127
    ds_write_b128 v212, v[48:51] offset:16384
    v_pk_fma_f32 v[128:129], v[128:129], v[22:23], v[22:23] op_sel:[0,1,0] op_sel_hi:[1,1,0] neg_lo:[0,0,1] neg_hi:[0,0,1]
    v_pk_fma_f32 v[130:131], v[130:131], v[22:23], v[22:23] op_sel:[0,1,0] op_sel_hi:[1,1,0] neg_lo:[0,0,1] neg_hi:[0,0,1]
    v_pk_fma_f32 v[132:133], v[132:133], v[22:23], v[22:23] op_sel:[0,1,0] op_sel_hi:[1,1,0] neg_lo:[0,0,1] neg_hi:[0,0,1]
    v_pk_fma_f32 v[134:135], v[134:135], v[22:23], v[22:23] op_sel:[0,1,0] op_sel_hi:[1,1,0] neg_lo:[0,0,1] neg_hi:[0,0,1]
    v_cvt_pk_bf16_f32 v52, v128, v129
    v_cvt_pk_bf16_f32 v53, v130, v131
    v_cvt_pk_bf16_f32 v54, v132, v133
    v_cvt_pk_bf16_f32 v55, v134, v135
    ds_write_b128 v212, v[52:55] offset:20480
    v_pk_fma_f32 v[136:137], v[136:137], v[20:21], v[20:21] op_sel:[0,1,0] op_sel_hi:[1,1,0] neg_lo:[0,0,1] neg_hi:[0,0,1]
    v_pk_fma_f32 v[138:139], v[138:139], v[20:21], v[20:21] op_sel:[0,1,0] op_sel_hi:[1,1,0] neg_lo:[0,0,1] neg_hi:[0,0,1]
    v_pk_fma_f32 v[140:141], v[140:141], v[20:21], v[20:21] op_sel:[0,1,0] op_sel_hi:[1,1,0] neg_lo:[0,0,1] neg_hi:[0,0,1]
    v_pk_fma_f32 v[142:143], v[142:143], v[20:21], v[20:21] op_sel:[0,1,0] op_sel_hi:[1,1,0] neg_lo:[0,0,1] neg_hi:[0,0,1]
    v_cvt_pk_bf16_f32 v56, v136, v137
    v_cvt_pk_bf16_f32 v57, v138, v139
    v_cvt_pk_bf16_f32 v58, v140, v141
    v_cvt_pk_bf16_f32 v59, v142, v143
    ds_write_b128 v212, v[56:59] offset:24576
    v_pk_fma_f32 v[144:145], v[144:145], v[22:23], v[22:23] op_sel:[0,1,0] op_sel_hi:[1,1,0] neg_lo:[0,0,1] neg_hi:[0,0,1]
    v_pk_fma_f32 v[146:147], v[146:147], v[22:23], v[22:23] op_sel:[0,1,0] op_sel_hi:[1,1,0] neg_lo:[0,0,1] neg_hi:[0,0,1]
    v_pk_fma_f32 v[148:149], v[148:149], v[22:23], v[22:23] op_sel:[0,1,0] op_sel_hi:[1,1,0] neg_lo:[0,0,1] neg_hi:[0,0,1]
    v_pk_fma_f32 v[150:151], v[150:151], v[22:23], v[22:23] op_sel:[0,1,0] op_sel_hi:[1,1,0] neg_lo:[0,0,1] neg_hi:[0,0,1]
    v_cvt_pk_bf16_f32 v60, v144, v145
    v_cvt_pk_bf16_f32 v61, v146, v147
    v_cvt_pk_bf16_f32 v62, v148, v149
    v_cvt_pk_bf16_f32 v63, v150, v151
    ds_write_b128 v212, v[60:63] offset:28672
    v_pk_fma_f32 v[152:153], v[152:153], v[20:21], v[20:21] op_sel:[0,1,0] op_sel_hi:[1,1,0] neg_lo:[0,0,1] neg_hi:[0,0,1]
    v_pk_fma_f32 v[154:155], v[154:155], v[20:21], v[20:21] op_sel:[0,1,0] op_sel_hi:[1,1,0] neg_lo:[0,0,1] neg_hi:[0,0,1]
    v_pk_fma_f32 v[156:157], v[156:157], v[20:21], v[20:21] op_sel:[0,1,0] op_sel_hi:[1,1,0] neg_lo:[0,0,1] neg_hi:[0,0,1]
    s_add_u32 m0, s6, 114688
    s_nop 0
    buffer_load_dwordx4 v8, s[12:15], s55 offen offset:0 lds
    v_pk_fma_f32 v[158:159], v[158:159], v[20:21], v[20:21] op_sel:[0,1,0] op_sel_hi:[1,1,0] neg_lo:[0,0,1] neg_hi:[0,0,1]
    v_cvt_pk_bf16_f32 v64, v152, v153
    v_cvt_pk_bf16_f32 v65, v154, v155
    v_cvt_pk_bf16_f32 v66, v156, v157
    v_cvt_pk_bf16_f32 v67, v158, v159
    ds_write_b128 v212, v[64:67] offset:32768
    v_pk_fma_f32 v[160:161], v[160:161], v[22:23], v[22:23] op_sel:[0,1,0] op_sel_hi:[1,1,0] neg_lo:[0,0,1] neg_hi:[0,0,1]
    v_pk_fma_f32 v[162:163], v[162:163], v[22:23], v[22:23] op_sel:[0,1,0] op_sel_hi:[1,1,0] neg_lo:[0,0,1] neg_hi:[0,0,1]
    v_pk_fma_f32 v[164:165], v[164:165], v[22:23], v[22:23] op_sel:[0,1,0] op_sel_hi:[1,1,0] neg_lo:[0,0,1] neg_hi:[0,0,1]
    buffer_load_dwordx4 v9, s[12:15], s55 offen offset:1024 lds
    v_pk_fma_f32 v[166:167], v[166:167], v[22:23], v[22:23] op_sel:[0,1,0] op_sel_hi:[1,1,0] neg_lo:[0,0,1] neg_hi:[0,0,1]
    v_cvt_pk_bf16_f32 v68, v160, v161
    v_cvt_pk_bf16_f32 v69, v162, v163
    v_cvt_pk_bf16_f32 v70, v164, v165
    v_cvt_pk_bf16_f32 v71, v166, v167
    ds_write_b128 v212, v[68:71] offset:36864
    v_pk_fma_f32 v[168:169], v[168:169], v[20:21], v[20:21] op_sel:[0,1,0] op_sel_hi:[1,1,0] neg_lo:[0,0,1] neg_hi:[0,0,1]
    v_pk_fma_f32 v[170:171], v[170:171], v[20:21], v[20:21] op_sel:[0,1,0] op_sel_hi:[1,1,0] neg_lo:[0,0,1] neg_hi:[0,0,1]
    v_pk_fma_f32 v[172:173], v[172:173], v[20:21], v[20:21] op_sel:[0,1,0] op_sel_hi:[1,1,0] neg_lo:[0,0,1] neg_hi:[0,0,1]
    buffer_load_dwordx4 v10, s[12:15], s55 offen offset:2048 lds
    v_pk_fma_f32 v[174:175], v[174:175], v[20:21], v[20:21] op_sel:[0,1,0] op_sel_hi:[1,1,0] neg_lo:[0,0,1] neg_hi:[0,0,1]
    v_cvt_pk_bf16_f32 v72, v168, v169
    v_cvt_pk_bf16_f32 v73, v170, v171
    v_cvt_pk_bf16_f32 v74, v172, v173
    v_cvt_pk_bf16_f32 v75, v174, v175
    ds_write_b128 v212, v[72:75] offset:40960
    v_pk_fma_f32 v[176:177], v[176:177], v[22:23], v[22:23] op_sel:[0,1,0] op_sel_hi:[1,1,0] neg_lo:[0,0,1] neg_hi:[0,0,1]
    v_pk_fma_f32 v[178:179], v[178:179], v[22:23], v[22:23] op_sel:[0,1,0] op_sel_hi:[1,1,0] neg_lo:[0,0,1] neg_hi:[0,0,1]
    v_pk_fma_f32 v[180:181], v[180:181], v[22:23], v[22:23] op_sel:[0,1,0] op_sel_hi:[1,1,0] neg_lo:[0,0,1] neg_hi:[0,0,1]
    buffer_load_dwordx4 v11, s[12:15], s55 offen offset:3072 lds
    s_add_u32 s55, s55, 172032
    s_cmp_eq_u32 s55, s60
    s_cselect_b32 s55, s58, s55
    v_pk_fma_f32 v[182:183], v[182:183], v[22:23], v[22:23] op_sel:[0,1,0] op_sel_hi:[1,1,0] neg_lo:[0,0,1] neg_hi:[0,0,1]
    v_cvt_pk_bf16_f32 v76, v176, v177
    v_cvt_pk_bf16_f32 v77, v178, v179
    v_cvt_pk_bf16_f32 v78, v180, v181
    v_cvt_pk_bf16_f32 v79, v182, v183
    ds_write_b128 v212, v[76:79] offset:45056
    v_pk_fma_f32 v[184:185], v[184:185], v[20:21], v[20:21] op_sel:[0,1,0] op_sel_hi:[1,1,0] neg_lo:[0,0,1] neg_hi:[0,0,1]
    v_pk_fma_f32 v[186:187], v[186:187], v[20:21], v[20:21] op_sel:[0,1,0] op_sel_hi:[1,1,0] neg_lo:[0,0,1] neg_hi:[0,0,1]
    v_pk_fma_f32 v[188:189], v[188:189], v[20:21], v[20:21] op_sel:[0,1,0] op_sel_hi:[1,1,0] neg_lo:[0,0,1] neg_hi:[0,0,1]
    v_pk_fma_f32 v[190:191], v[190:191], v[20:21], v[20:21] op_sel:[0,1,0] op_sel_hi:[1,1,0] neg_lo:[0,0,1] neg_hi:[0,0,1]
    v_cvt_pk_bf16_f32 v80, v184, v185
    v_cvt_pk_bf16_f32 v81, v186, v187
    v_cvt_pk_bf16_f32 v82, v188, v189
    v_cvt_pk_bf16_f32 v83, v190, v191
    ds_write_b128 v212, v[80:83] offset:49152
    v_pk_fma_f32 v[192:193], v[192:193], v[22:23], v[22:23] op_sel:[0,1,0] op_sel_hi:[1,1,0] neg_lo:[0,0,1] neg_hi:[0,0,1]
    v_pk_fma_f32 v[194:195], v[194:195], v[22:23], v[22:23] op_sel:[0,1,0] op_sel_hi:[1,1,0] neg_lo:[0,0,1] neg_hi:[0,0,1]
    v_pk_fma_f32 v[196:197], v[196:197], v[22:23], v[22:23] op_sel:[0,1,0] op_sel_hi:[1,1,0] neg_lo:[0,0,1] neg_hi:[0,0,1]
    v_pk_fma_f32 v[198:199], v[198:199], v[22:23], v[22:23] op_sel:[0,1,0] op_sel_hi:[1,1,0] neg_lo:[0,0,1] neg_hi:[0,0,1]
    v_cvt_pk_bf16_f32 v84, v192, v193
    v_cvt_pk_bf16_f32 v85, v194, v195
    v_cvt_pk_bf16_f32 v86, v196, v197
    v_cvt_pk_bf16_f32 v87, v198, v199
    ds_write_b128 v212, v[84:87] offset:53248
    s_add_u32 m0, s6, 131072
    s_nop 0
    buffer_load_dwordx4 v8, s[12:15], s55 offen offset:0 lds
    buffer_load_dwordx4 v9, s[12:15], s55 offen offset:1024 lds
    buffer_load_dwordx4 v10, s[12:15], s55 offen offset:2048 lds
    buffer_load_dwordx4 v11, s[12:15], s55 offen offset:3072 lds
    s_add_u32 s55, s55, 172032
    s_cmp_eq_u32 s55, s60
    s_cselect_b32 s55, s58, s55
    s_waitcnt vmcnt(16)
    s_waitcnt lgkmcnt(0)
    s_barrier
    ds_read_b128 a[0:3], v12 offset:0
    ds_read_b64_tr_b16 v[92:93], v16 offset:0
    ds_read_b64_tr_b16 v[94:95], v16 offset:512
    ds_read_b64_tr_b16 v[96:97], v218 offset:1024
    ds_read_b64_tr_b16 v[98:99], v218 offset:1536
    ds_read_b128 a[4:7], v13 offset:0
    ds_read_b64_tr_b16 v[104:105], v16 offset:4096
    ds_read_b64_tr_b16 v[106:107], v16 offset:4608
    ds_read_b64_tr_b16 v[108:109], v218 offset:5120
    ds_read_b64_tr_b16 v[110:111], v218 offset:5632
    s_waitcnt lgkmcnt(7)
    v_mfma_f32_32x32x16_bf16 v[128:143], a[0:3], v[92:95], 0
    ds_read_b128 a[8:11], v14 offset:0
    ds_read_b64_tr_b16 v[116:117], v16 offset:8192
    ds_read_b64_tr_b16 v[118:119], v16 offset:8704
    s_add_u32 m0, s6, 147456
    s_nop 0
    buffer_load_dwordx4 v8, s[12:15], s55 offen offset:0 lds
    buffer_load_dwordx4 v9, s[12:15], s55 offen offset:1024 lds
    s_waitcnt lgkmcnt(8)
    v_mfma_f32_32x32x16_bf16 v[144:159], a[0:3], v[96:99], 0
    ds_read_b64_tr_b16 v[120:121], v218 offset:9216
    ds_read_b64_tr_b16 v[122:123], v218 offset:9728
    v_mov_b32 v29, s65
    v_mov_b32 v30, s65
    v_mov_b32 v31, s65
    s_waitcnt lgkmcnt(5)
    v_mfma_f32_32x32x16_bf16 v[128:143], a[4:7], v[104:107], v[128:143]
    ds_read_b128 a[12:15], v15 offset:0
    ds_read_b64_tr_b16 v[92:93], v16 offset:12288
    ds_read_b64_tr_b16 v[94:95], v16 offset:12800
    s_mov_b32 s70, 0x3fb8aa3b
    s_mov_b32 s71, 0x3fb8aa3b
    buffer_load_dwordx4 v10, s[12:15], s55 offen offset:2048 lds
    v_mfma_f32_32x32x16_bf16 v[144:159], a[4:7], v[108:111], v[144:159]
    ds_read_b64_tr_b16 v[96:97], v218 offset:13312
    ds_read_b64_tr_b16 v[98:99], v218 offset:13824
    buffer_load_dwordx4 v11, s[12:15], s55 offen offset:3072 lds
    s_add_u32 s55, s55, 172032
    s_cmp_eq_u32 s55, s60
    s_cselect_b32 s55, s58, s55
    s_waitcnt lgkmcnt(5)
    v_mfma_f32_32x32x16_bf16 v[128:143], a[8:11], v[116:119], v[128:143]
    s_waitcnt vmcnt(16)
    s_barrier
    ds_read_b128 a[16:19], v12 offset:8192
    ds_read_b64_tr_b16 v[104:105], v16 offset:16384
    ds_read_b64_tr_b16 v[106:107], v16 offset:16896
    s_mov_b32 s72, 0x3f317218
    s_mov_b32 s73, 0x3f317218
    v_mfma_f32_32x32x16_bf16 v[144:159], a[8:11], v[120:123], v[144:159]
    ds_read_b64_tr_b16 v[108:109], v218 offset:17408
    ds_read_b64_tr_b16 v[110:111], v218 offset:17920
    v_mov_b32 v200, 0x35c1a2a0
    v_mov_b32 v201, 0x35c1a2a0
    v_lshlrev_b32 v224, 28, s48
    s_waitcnt lgkmcnt(5)
    v_mfma_f32_32x32x16_bf16 v[128:143], a[12:15], v[92:95], v[128:143]
    ds_read_b128 a[20:23], v13 offset:8192
    ds_read_b64_tr_b16 v[116:117], v16 offset:20480
    ds_read_b64_tr_b16 v[118:119], v16 offset:20992
    s_add_u32 s61, s5, 57344
    v_add_u32 v225, s61, v2
    v_xor_b32 v215, 2048, v225
    s_mov_b32 s44, 0x10000000
    v_mfma_f32_32x32x16_bf16 v[144:159], a[12:15], v[96:99], v[144:159]
    ds_read_b64_tr_b16 v[120:121], v218 offset:21504
    ds_read_b64_tr_b16 v[122:123], v218 offset:22016
    s_mov_b32 s45, s44
    v_mov_b32 v220, -1
    v_mov_b32 v221, -1
    s_waitcnt lgkmcnt(5)
    v_mfma_f32_32x32x16_bf16 v[128:143], a[16:19], v[104:107], v[128:143]
    ds_read_b128 a[24:27], v14 offset:8192
    ds_read_b64_tr_b16 v[92:93], v16 offset:24576
    ds_read_b64_tr_b16 v[94:95], v16 offset:25088
    v_mov_b32 v222, -1
    v_mov_b32 v223, -1
    s_lshl2_add_u32 s7, s2, s48
    s_lshl_b32 s7, s7, 10
    v_mfma_f32_32x32x16_bf16 v[144:159], a[16:19], v[108:111], v[144:159]
    ds_read_b64_tr_b16 v[96:97], v218 offset:25600
    ds_read_b64_tr_b16 v[98:99], v218 offset:26112
    s_add_u32 s7, s7, 13631488
    s_lshl2_add_u32 s79, s52, s48
    s_lshl_b32 s79, s79, 5
    s_add_u32 s79, s79, s51
    s_waitcnt lgkmcnt(5)
    v_mfma_f32_32x32x16_bf16 v[128:143], a[20:23], v[116:119], v[128:143]
    ds_read_b128 a[28:31], v15 offset:8192
    ds_read_b64_tr_b16 v[104:105], v16 offset:28672
    ds_read_b64_tr_b16 v[106:107], v16 offset:29184
    s_lshl_b32 s59, s79, 7
    s_add_u32 s59, s59, 1179648
    s_lshl_b32 s79, s79, 10
    v_and_b32 v4, 15, v1
    v_mfma_f32_32x32x16_bf16 v[144:159], a[20:23], v[120:123], v[144:159]
    ds_read_b64_tr_b16 v[108:109], v218 offset:29696
    ds_read_b64_tr_b16 v[110:111], v218 offset:30208
    v_lshrrev_b32 v5, 4, v1
    v_lshlrev_b32 v6, 2, v5
    v_sub_u32 v7, v4, v6
    s_waitcnt lgkmcnt(5)
    v_mfma_f32_32x32x16_bf16 v[128:143], a[24:27], v[92:95], v[128:143]
    s_waitcnt vmcnt(12)
    s_barrier
    ds_read_b128 a[32:35], v12 offset:16384
    ds_read_b64_tr_b16 v[116:117], v16 offset:32768
    ds_read_b64_tr_b16 v[118:119], v16 offset:33280
    v_and_b32 v7, 15, v7
    v_mul_u32_u24 v228, 896, v5
    v_mfma_f32_32x32x16_bf16 v[144:159], a[24:27], v[96:99], v[144:159]
    ds_read_b64_tr_b16 v[120:121], v218 offset:33792
    ds_read_b64_tr_b16 v[122:123], v218 offset:34304
    v_lshl_add_u32 v228, v7, 4, v228
    s_add_u32 s61, s75, 1
    s_lshl_b32 s61, s61, 1
    v_and_b32 v6, s61, v7
    s_waitcnt lgkmcnt(5)
    v_mfma_f32_32x32x16_bf16 v[128:143], a[28:31], v[104:107], v[128:143]
    ds_read_b128 a[36:39], v13 offset:16384
    ds_read_b64_tr_b16 v[92:93], v16 offset:36864
    ds_read_b64_tr_b16 v[94:95], v16 offset:37376
    v_and_b32 v6, 8, v6
    v_lshl_or_b32 v228, v6, 27, v228
    s_mul_i32 s68, s48, 14336
    v_mfma_f32_32x32x16_bf16 v[144:159], a[28:31], v[108:111], v[144:159]
    ds_read_b64_tr_b16 v[96:97], v218 offset:37888
    ds_read_b64_tr_b16 v[98:99], v218 offset:38400
    s_lshl_b32 s61, s75, 8
    s_add_u32 m0, s6, 65536
    s_nop 0
    buffer_load_dwordx4 v8, s[12:15], s55 offen offset:0 lds
    s_waitcnt lgkmcnt(5)
    v_mfma_f32_32x32x16_bf16 v[128:143], a[32:35], v[116:119], v[128:143]
    ds_read_b128 a[40:43], v14 offset:16384
    ds_read_b64_tr_b16 v[104:105], v16 offset:40960
    ds_read_b64_tr_b16 v[106:107], v16 offset:41472
    s_add_u32 s68, s68, s61
    buffer_load_dwordx4 v9, s[12:15], s55 offen offset:1024 lds
    v_mfma_f32_32x32x16_bf16 v[144:159], a[32:35], v[120:123], v[144:159]
    ds_read_b64_tr_b16 v[108:109], v218 offset:41984
    ds_read_b64_tr_b16 v[110:111], v218 offset:42496
    v_add_u32 v229, 2560, v228
    v_add_u32 v230, 5120, v228
    v_add_u32 v231, 7680, v228
    s_and_b32 s61, s50, 7
    s_waitcnt lgkmcnt(5)
    v_mfma_f32_32x32x16_bf16 v[128:143], a[36:39], v[92:95], v[128:143]
    ds_read_b128 a[44:47], v15 offset:16384
    ds_read_b64_tr_b16 v[116:117], v16 offset:45056
    ds_read_b64_tr_b16 v[118:119], v16 offset:45568
    s_lshl3_add_u32 s74, s49, s61
    buffer_load_dwordx4 v10, s[12:15], s55 offen offset:2048 lds
    v_mfma_f32_32x32x16_bf16 v[144:159], a[36:39], v[96:99], v[144:159]
    ds_read_b64_tr_b16 v[120:121], v218 offset:46080
    ds_read_b64_tr_b16 v[122:123], v218 offset:46592
    buffer_load_dwordx4 v11, s[12:15], s55 offen offset:3072 lds
    s_add_u32 s55, s55, 172032
    s_cmp_eq_u32 s55, s60
    s_cselect_b32 s55, s58, s55
    s_waitcnt lgkmcnt(5)
    v_mfma_f32_32x32x16_bf16 v[128:143], a[40:43], v[104:107], v[128:143]
    s_waitcnt vmcnt(12)
    s_barrier
    ds_read_b128 a[48:51], v12 offset:24576
    ds_read_b64_tr_b16 v[92:93], v16 offset:49152
    ds_read_b64_tr_b16 v[94:95], v16 offset:49664
    s_cmp_eq_u32 s52, 7
    s_cbranch_scc1 L_red
    v_mfma_f32_32x32x16_bf16 v[144:159], a[40:43], v[108:111], v[144:159]
    ds_read_b64_tr_b16 v[96:97], v218 offset:50176
    ds_read_b64_tr_b16 v[98:99], v218 offset:50688
    s_and_b32 s63, s48, 1
    s_lshl1_add_u32 s61, s51, s63
    s_mov_b32 exec_hi, 0xff
    buffer_store_dwordx4 v[220:223], v2, s[16:19], s7 offen sc1
    s_mov_b32 exec_hi, -1
    s_waitcnt lgkmcnt(5)
    v_mfma_f32_32x32x16_bf16 v[128:143], a[44:47], v[116:119], v[128:143]
    ds_read_b128 a[52:55], v13 offset:24576
    ds_read_b64_tr_b16 v[104:105], v16 offset:53248
    ds_read_b64_tr_b16 v[106:107], v16 offset:53760
    s_mul_i32 s56, s61, 28672
    s_lshl_b32 s63, s54, 5
    s_add_u32 s56, s56, s63
    s_lshr_b32 s63, s48, 1
    s_lshl_b32 s63, s63, 11
    v_mfma_f32_32x32x16_bf16 v[144:159], a[44:47], v[120:123], v[144:159]
    ds_read_b64_tr_b16 v[108:109], v218 offset:54272
    ds_read_b64_tr_b16 v[110:111], v218 offset:54784
    s_add_u32 s56, s56, s63
    s_add_u32 s56, s56, 2097152
    s_lshl_b32 s57, s61, 11
    s_lshl1_add_u32 s57, s54, s57
    s_lshr_b32 s63, s63, 4
    s_add_u32 s57, s57, s63
    s_waitcnt lgkmcnt(5)
    v_mfma_f32_32x32x16_bf16 v[128:143], a[48:51], v[92:95], v[128:143]
    ds_read_b128 a[56:59], v14 offset:24576
    ds_read_b64_tr_b16 v[116:117], v16 offset:57344
    ds_read_b64_tr_b16 v[118:119], v16 offset:57856
    s_add_u32 s57, s57, 1048576
    s_add_u32 m0, s6, 81920
    s_nop 0
    buffer_load_dwordx4 v216, s[12:15], s67 offen offset:0 lds
    v_mfma_f32_32x32x16_bf16 v[144:159], a[48:51], v[96:99], v[144:159]
    ds_read_b64_tr_b16 v[120:121], v218 offset:58368
    ds_read_b64_tr_b16 v[122:123], v218 offset:58880
    s_waitcnt lgkmcnt(5)
    v_mfma_f32_32x32x16_bf16 v[128:143], a[52:55], v[104:107], v[128:143]
    ds_read_b128 a[60:63], v15 offset:24576
    ds_read_b64_tr_b16 v[92:93], v16 offset:61440
    ds_read_b64_tr_b16 v[94:95], v16 offset:61952
    v_mfma_f32_32x32x16_bf16 v[144:159], a[52:55], v[108:111], v[144:159]
    ds_read_b64_tr_b16 v[96:97], v218 offset:62464
    ds_read_b64_tr_b16 v[98:99], v218 offset:62976
    buffer_load_dwordx4 v217, s[12:15], s67 offen offset:2048 lds
    s_add_u32 s67, s67, 172032
    s_cmp_eq_u32 s67, s81
    s_cselect_b32 s67, s54, s67
    s_waitcnt lgkmcnt(5)
    v_mfma_f32_32x32x16_bf16 v[128:143], a[56:59], v[116:119], v[128:143]
    s_waitcnt vmcnt(11)
    s_barrier
    ds_read_b128 a[64:67], v12 offset:32768
    ds_read_b64_tr_b16 v[104:105], v17 offset:0
    ds_read_b64_tr_b16 v[106:107], v17 offset:512
    s_lshl2_add_u32 s63, s50, s48
    v_mfma_f32_32x32x16_bf16 v[144:159], a[56:59], v[120:123], v[144:159]
    ds_read_b64_tr_b16 v[108:109], v219 offset:1024
    ds_read_b64_tr_b16 v[110:111], v219 offset:1536
    s_lshr_b32 s64, s49, 2
    s_and_b32 s66, s49, 1
    buffer_load_dword v214, off, s[40:43], 0 sc1
    s_waitcnt lgkmcnt(5)
    v_mfma_f32_32x32x16_bf16 v[128:143], a[60:63], v[92:95], v[128:143]
    ds_read_b128 a[68:71], v13 offset:32768
    ds_read_b64_tr_b16 v[116:117], v17 offset:4096
    ds_read_b64_tr_b16 v[118:119], v17 offset:4608
    s_lshl1_add_u32 s64, s64, s66
    s_mulk_i32 s64, 112
    s_add_u32 s64, s64, s63
    v_mfma_f32_32x32x16_bf16 v[144:159], a[60:63], v[96:99], v[144:159]
    ds_read_b64_tr_b16 v[120:121], v219 offset:5120
    ds_read_b64_tr_b16 v[122:123], v219 offset:5632
    s_bfe_u32 s66, s49, 0x10001
    s_add_u32 m0, s6, 82944
    s_nop 0
    buffer_load_dwordx4 v216, s[12:15], s67 offen offset:0 lds
    s_waitcnt lgkmcnt(5)
    v_mfma_f32_32x32x16_bf16 v[128:143], a[64:67], v[104:107], v[128:143]
    ds_read_b128 a[72:75], v14 offset:32768
    ds_read_b64_tr_b16 v[92:93], v17 offset:8192
    ds_read_b64_tr_b16 v[94:95], v17 offset:8704
    buffer_load_dwordx4 v217, s[12:15], s67 offen offset:2048 lds
    s_add_u32 s67, s67, 172032
    s_cmp_eq_u32 s67, s81
    s_cselect_b32 s67, s54, s67
    v_mfma_f32_32x32x16_bf16 v[144:159], a[64:67], v[108:111], v[144:159]
    ds_read_b64_tr_b16 v[96:97], v219 offset:9216
    ds_read_b64_tr_b16 v[98:99], v219 offset:9728
    s_lshl1_add_u32 s64, s64, s66
    s_mulk_i32 s64, 1792
    s_mulk_i32 s63, 3584
    v_lshlrev_b32 v227, 7, v1
    s_waitcnt lgkmcnt(5)
    v_mfma_f32_32x32x16_bf16 v[128:143], a[68:71], v[116:119], v[128:143]
    ds_read_b128 a[76:79], v15 offset:32768
    ds_read_b64_tr_b16 v[104:105], v17 offset:12288
    ds_read_b64_tr_b16 v[106:107], v17 offset:12800
    s_add_u32 m0, s6, 98304
    s_nop 0
    buffer_load_dwordx4 v216, s[12:15], s67 offen offset:0 lds
    v_mfma_f32_32x32x16_bf16 v[144:159], a[68:71], v[120:123], v[144:159]
    ds_read_b64_tr_b16 v[108:109], v219 offset:13312
    ds_read_b64_tr_b16 v[110:111], v219 offset:13824
    buffer_load_dwordx4 v217, s[12:15], s67 offen offset:2048 lds
    s_add_u32 s67, s67, 172032
    s_cmp_eq_u32 s67, s81
    s_cselect_b32 s67, s54, s67
    s_waitcnt lgkmcnt(5)
    v_mfma_f32_32x32x16_bf16 v[128:143], a[72:75], v[92:95], v[128:143]
    s_waitcnt vmcnt(12)
    s_barrier
    ds_read_b128 a[80:83], v12 offset:40960
    ds_read_b64_tr_b16 v[116:117], v17 offset:16384
    ds_read_b64_tr_b16 v[118:119], v17 offset:16896
    v_mfma_f32_32x32x16_bf16 v[144:159], a[72:75], v[96:99], v[144:159]
    ds_read_b64_tr_b16 v[120:121], v219 offset:17408
    ds_read_b64_tr_b16 v[122:123], v219 offset:17920
    s_waitcnt lgkmcnt(5)
    v_mfma_f32_32x32x16_bf16 v[128:143], a[76:79], v[104:107], v[128:143]
    ds_read_b128 a[84:87], v13 offset:40960
    ds_read_b64_tr_b16 v[92:93], v17 offset:20480
    ds_read_b64_tr_b16 v[94:95], v17 offset:20992
    v_mfma_f32_32x32x16_bf16 v[144:159], a[76:79], v[108:111], v[144:159]
    ds_read_b64_tr_b16 v[96:97], v219 offset:21504
    ds_read_b64_tr_b16 v[98:99], v219 offset:22016
    s_add_u32 m0, s6, 99328
    s_nop 0
    buffer_load_dwordx4 v216, s[12:15], s67 offen offset:0 lds
    s_waitcnt lgkmcnt(5)
    v_mfma_f32_32x32x16_bf16 v[128:143], a[80:83], v[116:119], v[128:143]
    ds_read_b128 a[88:91], v14 offset:40960
    ds_read_b64_tr_b16 v[104:105], v17 offset:24576
    ds_read_b64_tr_b16 v[106:107], v17 offset:25088
    buffer_load_dwordx4 v217, s[12:15], s67 offen offset:2048 lds
    s_add_u32 s67, s67, 172032
    s_cmp_eq_u32 s67, s81
    s_cselect_b32 s67, s54, s67
    v_mfma_f32_32x32x16_bf16 v[144:159], a[80:83], v[120:123], v[144:159]
    ds_read_b64_tr_b16 v[108:109], v219 offset:25600
    ds_read_b64_tr_b16 v[110:111], v219 offset:26112
    s_waitcnt lgkmcnt(5)
    v_mfma_f32_32x32x16_bf16 v[128:143], a[84:87], v[92:95], v[128:143]
    ds_read_b128 a[92:95], v15 offset:40960
    ds_read_b64_tr_b16 v[116:117], v17 offset:28672
    ds_read_b64_tr_b16 v[118:119], v17 offset:29184
    s_add_u32 m0, s6, 114688
    s_nop 0
    buffer_load_dwordx4 v216, s[12:15], s67 offen offset:0 lds
    v_mfma_f32_32x32x16_bf16 v[144:159], a[84:87], v[96:99], v[144:159]
    ds_read_b64_tr_b16 v[120:121], v219 offset:29696
    ds_read_b64_tr_b16 v[122:123], v219 offset:30208
    buffer_load_dwordx4 v217, s[12:15], s67 offen offset:2048 lds
    s_add_u32 s67, s67, 172032
    s_cmp_eq_u32 s67, s81
    s_cselect_b32 s67, s54, s67
    s_waitcnt lgkmcnt(5)
    v_mfma_f32_32x32x16_bf16 v[128:143], a[88:91], v[104:107], v[128:143]
    s_waitcnt vmcnt(12)
    s_barrier
    ds_read_b128 a[96:99], v12 offset:49152
    ds_read_b64_tr_b16 v[92:93], v16 offset:0
    ds_read_b64_tr_b16 v[94:95], v16 offset:512
    v_mfma_f32_32x32x16_bf16 v[144:159], a[88:91], v[108:111], v[144:159]
    ds_read_b64_tr_b16 v[96:97], v218 offset:1024
    ds_read_b64_tr_b16 v[98:99], v218 offset:1536
    s_add_u32 m0, s6, 115712
    s_nop 0
    buffer_load_dwordx4 v216, s[12:15], s67 offen offset:0 lds
    s_waitcnt lgkmcnt(5)
    v_mfma_f32_32x32x16_bf16 v[128:143], a[92:95], v[116:119], v[128:143]
    ds_read_b128 a[100:103], v13 offset:49152
    ds_read_b64_tr_b16 v[104:105], v16 offset:4096
    ds_read_b64_tr_b16 v[106:107], v16 offset:4608
    v_mfma_f32_32x32x16_bf16 v[144:159], a[92:95], v[120:123], v[144:159]
    ds_read_b64_tr_b16 v[108:109], v218 offset:5120
    ds_read_b64_tr_b16 v[110:111], v218 offset:5632
    buffer_load_dwordx4 v217, s[12:15], s67 offen offset:2048 lds
    s_add_u32 s67, s67, 172032
    s_cmp_eq_u32 s67, s81
    s_cselect_b32 s67, s54, s67
    s_waitcnt lgkmcnt(5)
    v_mfma_f32_32x32x16_bf16 v[128:143], a[96:99], v[92:95], v[128:143]
    ds_read_b128 a[104:107], v14 offset:49152
    ds_read_b64_tr_b16 v[116:117], v16 offset:8192
    ds_read_b64_tr_b16 v[118:119], v16 offset:8704
    v_mfma_f32_32x32x16_bf16 v[144:159], a[96:99], v[96:99], v[144:159]
    ds_read_b64_tr_b16 v[120:121], v218 offset:9216
    ds_read_b64_tr_b16 v[122:123], v218 offset:9728
    s_waitcnt lgkmcnt(5)
    v_mfma_f32_32x32x16_bf16 v[128:143], a[100:103], v[104:107], v[128:143]
    ds_read_b128 a[108:111], v15 offset:49152
    ds_read_b64_tr_b16 v[92:93], v16 offset:12288
    ds_read_b64_tr_b16 v[94:95], v16 offset:12800
    s_add_u32 m0, s6, 131072
    s_nop 0
    buffer_load_dwordx4 v216, s[12:15], s67 offen offset:0 lds
    v_mfma_f32_32x32x16_bf16 v[144:159], a[100:103], v[108:111], v[144:159]
    ds_read_b64_tr_b16 v[96:97], v218 offset:13312
    ds_read_b64_tr_b16 v[98:99], v218 offset:13824
    s_waitcnt lgkmcnt(5)
    v_mfma_f32_32x32x16_bf16 v[128:143], a[104:107], v[116:119], v[128:143]
    buffer_load_dwordx4 v217, s[12:15], s67 offen offset:2048 lds
    s_add_u32 s67, s67, 172032
    s_cmp_eq_u32 s67, s81
    s_cselect_b32 s67, s54, s67
    v_mfma_f32_32x32x16_bf16 v[144:159], a[104:107], v[120:123], v[144:159]
    s_waitcnt lgkmcnt(0)
    v_mfma_f32_32x32x16_bf16 v[128:143], a[108:111], v[92:95], v[128:143]
    v_mfma_f32_32x32x16_bf16 v[144:159], a[108:111], v[96:99], v[144:159]
    s_waitcnt vmcnt(12)
    v_cmp_gt_u32 vcc, 32, v214
    s_nop 0
    s_cmp_lg_u32 vcc_lo, 0
    s_cbranch_scc1 L_init_no
L_init_ok:
    s_nop 5
    v_pk_fma_f32 v[128:129], v[128:129], s[70:71], v[200:201]
    v_pk_fma_f32 v[130:131], v[130:131], s[70:71], v[200:201]
    v_pk_fma_f32 v[132:133], v[132:133], s[70:71], v[200:201]
    v_pk_fma_f32 v[134:135], v[134:135], s[70:71], v[200:201]
    v_exp_f32 v202, v128 clamp
    v_exp_f32 v203, v129 clamp
    v_max_f32 v128, v200, v128
    v_max_f32 v129, v200, v129
    v_pk_fma_f32 v[128:129], v[128:129], s[72:73], v[202:203]
    v_exp_f32 v204, v130 clamp
    v_exp_f32 v205, v131 clamp
    v_max_f32 v130, v200, v130
    s_waitcnt vmcnt(6)
    s_barrier
    ds_read_b64_tr_b16 v[64:65], v18 offset:16384
    ds_read_b64_tr_b16 v[66:67], v18 offset:16896
    ds_read_b64_tr_b16 v[68:69], v18 offset:20480
    ds_read_b64_tr_b16 v[70:71], v18 offset:20992
    ds_read_b64_tr_b16 v[72:73], v18 offset:24576
    ds_read_b64_tr_b16 v[74:75], v18 offset:25088
    ds_read_b64_tr_b16 v[76:77], v18 offset:28672
    ds_read_b64_tr_b16 v[78:79], v18 offset:29184
    ds_read_b64_tr_b16 v[80:81], v18 offset:17408
    ds_read_b64_tr_b16 v[82:83], v18 offset:17920
    s_mov_b64 exec, 0x3fff
    buffer_load_dword v226, v227, s[24:27], s64 offen
    buffer_load_dword v226, v227, s[28:31], s64 offen
    s_mov_b64 exec, -1
    v_max_f32 v131, v200, v131
    v_pk_fma_f32 v[130:131], v[130:131], s[72:73], v[204:205]
    v_exp_f32 v206, v132 clamp
    v_exp_f32 v207, v133 clamp
    v_max_f32 v132, v200, v132
    v_max_f32 v133, v200, v133
    v_pk_fma_f32 v[132:133], v[132:133], s[72:73], v[206:207]
    v_exp_f32 v208, v134 clamp
    v_exp_f32 v209, v135 clamp
    v_max_f32 v134, v200, v134
    v_max_f32 v135, v200, v135
    v_pk_fma_f32 v[134:135], v[134:135], s[72:73], v[208:209]
    v_cvt_pk_bf16_f32 v56, v144, v145
    v_cvt_pk_bf16_f32 v48, v128, v129
    v_cndmask_b32 v56, v56, v28, s[44:45]
    v_cvt_pk_bf16_f32 v57, v146, v147
    v_cvt_pk_bf16_f32 v49, v130, v131
    v_cndmask_b32 v57, v57, v28, s[44:45]
    v_cvt_pk_bf16_f32 v58, v148, v149
    v_cvt_pk_bf16_f32 v50, v132, v133
    v_cndmask_b32 v58, v58, v28, s[44:45]
    v_cvt_pk_bf16_f32 v59, v150, v151
    v_cvt_pk_bf16_f32 v51, v134, v135
    v_cndmask_b32 v59, v59, v28, s[44:45]
    s_nop 1
    v_mfma_f32_32x32x16_bf16 v[176:191], v[48:51], v[56:59], 0
    s_waitcnt lgkmcnt(8)
    v_mfma_f32_32x32x16_bf16 v[32:47], v[64:67], a[0:3], 0
    ds_read_b64_tr_b16 v[84:85], v18 offset:21504
    ds_read_b64_tr_b16 v[86:87], v18 offset:22016
    v_fma_f32 v136, v136, s70, v200
    v_fma_f32 v137, v137, s70, v200
    v_fma_f32 v138, v138, s70, v200
    v_fma_f32 v139, v139, s70, v200
    v_exp_f32 v202, v136 clamp
    v_max_f32 v136, v200, v136
    v_exp_f32 v203, v137 clamp
    s_waitcnt lgkmcnt(8)
    v_mfma_f32_32x32x16_bf16 v[32:47], v[68:71], a[4:7], v[32:47]
    ds_read_b64_tr_b16 v[64:65], v18 offset:25600
    ds_read_b64_tr_b16 v[66:67], v18 offset:26112
    v_max_f32 v137, v200, v137
    v_exp_f32 v204, v138 clamp
    v_max_f32 v138, v200, v138
    v_exp_f32 v205, v139 clamp
    v_max_f32 v139, v200, v139
    s_waitcnt lgkmcnt(6)
    v_mfma_f32_32x32x16_bf16 v[32:47], v[72:75], a[8:11], v[32:47]
    ds_read_b64_tr_b16 v[68:69], v18 offset:29696
    ds_read_b64_tr_b16 v[70:71], v18 offset:30208
    v_fma_f32 v136, v136, s72, v202
    v_fma_f32 v137, v137, s72, v203
    v_fma_f32 v138, v138, s72, v204
    v_fma_f32 v139, v139, s72, v205
    v_fma_f32 v140, v140, s70, v200
    v_fma_f32 v141, v141, s70, v200
    v_fma_f32 v142, v142, s70, v200
    v_fma_f32 v143, v143, s70, v200
    v_mfma_f32_32x32x16_bf16 v[32:47], v[76:79], a[12:15], v[32:47]
    ds_read_b64_tr_b16 v[72:73], v18 offset:32768
    ds_read_b64_tr_b16 v[74:75], v18 offset:33280
    v_exp_f32 v206, v140 clamp
    v_max_f32 v140, v200, v140
    v_exp_f32 v207, v141 clamp
    v_max_f32 v141, v200, v141
    v_exp_f32 v208, v142 clamp
    s_waitcnt lgkmcnt(6)
    v_mfma_f32_32x32x16_bf16 v[32:47], v[80:83], a[16:19], v[32:47]
    ds_read_b64_tr_b16 v[76:77], v18 offset:36864
    ds_read_b64_tr_b16 v[78:79], v18 offset:37376
    s_mov_b64 exec, 1
    buffer_store_dword v28, off, s[16:19], s59 sc1
    s_mov_b64 exec, -1
    v_max_f32 v142, v200, v142
    v_exp_f32 v209, v143 clamp
    v_max_f32 v143, v200, v143
    v_mfma_f32_32x32x16_bf16 v[32:47], v[84:87], a[20:23], v[32:47]
    ds_read_b64_tr_b16 v[80:81], v18 offset:40960
    ds_read_b64_tr_b16 v[82:83], v18 offset:41472
    v_fma_f32 v140, v140, s72, v206
    v_fma_f32 v141, v141, s72, v207
    v_fma_f32 v142, v142, s72, v208
    v_fma_f32 v143, v143, s72, v209
    v_cvt_pk_bf16_f32 v60, v152, v153
    v_cvt_pk_bf16_f32 v52, v136, v137
    v_cndmask_b32 v60, v60, v28, s[44:45]
    v_cvt_pk_bf16_f32 v61, v154, v155
    s_waitcnt lgkmcnt(6)
    v_mfma_f32_32x32x16_bf16 v[32:47], v[64:67], a[24:27], v[32:47]
    ds_read_b64_tr_b16 v[84:85], v18 offset:45056
    ds_read_b64_tr_b16 v[86:87], v18 offset:45568
    v_cvt_pk_bf16_f32 v53, v138, v139
    v_cndmask_b32 v61, v61, v28, s[44:45]
    v_cvt_pk_bf16_f32 v62, v156, v157
    v_cvt_pk_bf16_f32 v54, v140, v141
    v_cndmask_b32 v62, v62, v28, s[44:45]
    v_cvt_pk_bf16_f32 v63, v158, v159
    v_cvt_pk_bf16_f32 v55, v142, v143
    v_cndmask_b32 v63, v63, v28, s[44:45]
    s_nop 1
    v_mfma_f32_32x32x16_bf16 v[176:191], v[52:55], v[60:63], v[176:191]
    v_mfma_f32_32x32x16_bf16 v[32:47], v[68:71], a[28:31], v[32:47]
    ds_read_b64_tr_b16 v[64:65], v18 offset:33792
    ds_read_b64_tr_b16 v[66:67], v18 offset:34304
    s_waitcnt lgkmcnt(6)
    v_mfma_f32_32x32x16_bf16 v[32:47], v[72:75], a[32:35], v[32:47]
    ds_read_b64_tr_b16 v[68:69], v18 offset:37888
    ds_read_b64_tr_b16 v[70:71], v18 offset:38400
    s_nop 4
    ds_write_b128 v225, v[184:187] offset:0
    v_mfma_f32_32x32x16_bf16 v[32:47], v[76:79], a[36:39], v[32:47]
    ds_write_b128 v225, v[188:191] offset:1024
    ds_read_b64_tr_b16 v[72:73], v18 offset:41984
    ds_read_b64_tr_b16 v[74:75], v18 offset:42496
    s_waitcnt lgkmcnt(8)
    v_mfma_f32_32x32x16_bf16 v[32:47], v[80:83], a[40:43], v[32:47]
    ds_read_b64_tr_b16 v[76:77], v18 offset:46080
    ds_read_b64_tr_b16 v[78:79], v18 offset:46592
    s_waitcnt vmcnt(3) lgkmcnt(4)
    s_barrier
    ds_read_b128 v[88:91], v215 offset:0
    ds_read_b128 v[92:95], v215 offset:1024
    v_mfma_f32_32x32x16_bf16 v[32:47], v[84:87], a[44:47], v[32:47]
    ds_read_b64_tr_b16 v[80:81], v18 offset:49152
    ds_read_b64_tr_b16 v[82:83], v18 offset:49664
    v_mfma_f32_32x32x16_bf16 v[32:47], v[64:67], a[48:51], v[32:47]
    ds_read_b64_tr_b16 v[84:85], v18 offset:53248
    ds_read_b64_tr_b16 v[86:87], v18 offset:53760
    v_mfma_f32_32x32x16_bf16 v[32:47], v[68:71], a[52:55], v[32:47]
    ds_read_b64_tr_b16 v[64:65], v18 offset:57344
    ds_read_b64_tr_b16 v[66:67], v18 offset:57856
    s_waitcnt lgkmcnt(7)
    v_add_f32 v88, v88, v176
    v_add_f32 v89, v89, v177
    v_cvt_pk_bf16_f32 v96, v88, v89
    v_add_f32 v90, v90, v178
    v_add_f32 v91, v91, v179
    v_cvt_pk_bf16_f32 v97, v90, v91
    s_waitcnt lgkmcnt(6)
    v_add_f32 v92, v92, v180
    v_mfma_f32_32x32x16_bf16 v[32:47], v[72:75], a[56:59], v[32:47]
    ds_read_b64_tr_b16 v[68:69], v18 offset:61440
    ds_read_b64_tr_b16 v[70:71], v18 offset:61952
    v_add_f32 v93, v93, v181
    v_cvt_pk_bf16_f32 v98, v92, v93
    v_add_f32 v94, v94, v182
    v_add_f32 v95, v95, v183
    v_cvt_pk_bf16_f32 v99, v94, v95
    buffer_store_dwordx4 v[96:99], v2, s[16:19], s79 offen sc1
    v_mfma_f32_32x32x16_bf16 v[32:47], v[76:79], a[60:63], v[32:47]
    ds_read_b64_tr_b16 v[72:73], v18 offset:50176
    ds_read_b64_tr_b16 v[74:75], v18 offset:50688
    s_add_u32 m0, s6, 0
    s_nop 0
    buffer_load_dwordx4 v228, s[20:23], s68 offen offset:0 lds
    s_waitcnt lgkmcnt(6)
    v_mfma_f32_32x32x16_bf16 v[32:47], v[80:83], a[64:67], v[32:47]
    ds_read_b64_tr_b16 v[76:77], v18 offset:54272
    ds_read_b64_tr_b16 v[78:79], v18 offset:54784
    s_mul_i32 s61, s50, 37
    s_lshr_b32 s61, s61, 8
    s_mul_i32 s62, s61, 7
    s_sub_u32 s80, s50, s62
    s_and_b32 s62, s49, 1
    v_mfma_f32_32x32x16_bf16 v[32:47], v[84:87], a[68:71], v[32:47]
    ds_read_b64_tr_b16 v[80:81], v18 offset:58368
    ds_read_b64_tr_b16 v[82:83], v18 offset:58880
    buffer_load_dwordx4 v229, s[20:23], s68 offen offset:1024 lds
    s_mul_i32 s62, s62, 28
    s_waitcnt lgkmcnt(6)
    v_mfma_f32_32x32x16_bf16 v[32:47], v[64:67], a[72:75], v[32:47]
    ds_read_b64_tr_b16 v[84:85], v18 offset:62464
    ds_read_b64_tr_b16 v[86:87], v18 offset:62976
    s_add_u32 s62, s62, s50
    s_and_b32 s76, s49, 4
    s_and_b32 s77, s62, 7
    s_lshl1_add_u32 s76, s76, s77
    v_mfma_f32_32x32x16_bf16 v[32:47], v[68:71], a[76:79], v[32:47]
    ds_read_b64_tr_b16 v[64:65], v19 offset:0
    ds_read_b64_tr_b16 v[66:67], v19 offset:512
    s_bfe_u32 s77, s49, 0x10001
    s_mul_i32 s77, s77, 7
    s_lshr_b32 s62, s62, 3
    s_add_u32 s77, s77, s62
    s_waitcnt lgkmcnt(6)
    v_mfma_f32_32x32x16_bf16 v[32:47], v[72:75], a[80:83], v[32:47]
    ds_read_b64_tr_b16 v[68:69], v19 offset:4096
    ds_read_b64_tr_b16 v[70:71], v19 offset:4608
    buffer_load_dwordx4 v230, s[20:23], s68 offen offset:2048 lds
    s_lshr_b32 s62, s61, 1
    s_lshl1_add_u32 s78, s49, s62
    v_mfma_f32_32x32x16_bf16 v[32:47], v[76:79], a[84:87], v[32:47]
    ds_read_b64_tr_b16 v[72:73], v19 offset:8192
    ds_read_b64_tr_b16 v[74:75], v19 offset:8704
    s_and_b32 s62, s61, 1
    s_lshl2_add_u32 s78, s78, s62
    v_lshrrev_b32 v4, 3, v1
    s_waitcnt lgkmcnt(6)
    v_mfma_f32_32x32x16_bf16 v[32:47], v[80:83], a[88:91], v[32:47]
    ds_read_b64_tr_b16 v[76:77], v19 offset:12288
    ds_read_b64_tr_b16 v[78:79], v19 offset:12800
    buffer_load_dwordx4 v231, s[20:23], s68 offen offset:3072 lds
    s_add_u32 s68, s68, 57344
    v_mul_u32_u24 v4, 3584, v4
    v_mfma_f32_32x32x16_bf16 v[32:47], v[84:87], a[92:95], v[32:47]
    v_and_b32 v5, 0x70, v216
    v_add_u32 v240, v4, v5
    v_add_u32 v241, 27648, v240
    v_xor_b32 v242, 32, v240
    v_xor_b32 v243, 32, v241
    s_mul_i32 s69, s48, 57344
    s_waitcnt lgkmcnt(4)
    v_mfma_f32_32x32x16_bf16 v[32:47], v[64:67], a[96:99], v[32:47]
    s_lshl_b32 s61, s77, 8
    s_add_u32 s69, s69, s61
    v_and_b32 v4, 1, v1
    v_bfe_u32 v5, v1, 1, 1
    v_lshl_add_u32 v4, v4, 1, v5
    v_lshlrev_b32 v4, 3, v4
    v_bfe_u32 v5, v1, 4, 1
    v_mfma_f32_32x32x16_bf16 v[32:47], v[68:71], a[100:103], v[32:47]
    s_add_u32 m0, s6, 16384
    s_nop 0
    buffer_load_dwordx4 v228, s[20:23], s68 offen offset:0 lds
    v_add_u32 v6, s48, v26
    v_and_b32 v6, 3, v6
    v_lshl_add_u32 v4, v6, 6, v4
    s_waitcnt lgkmcnt(0)
    v_mfma_f32_32x32x16_bf16 v[32:47], v[72:75], a[104:107], v[32:47]
    v_lshl_add_u32 v4, v27, 1, v4
    v_lshl_add_u32 v244, v5, 5, v4
    v_add_u32 v245, 0x10000, v244
    v_add_u32 v246, 0x20000, v244
    v_and_b32 v4, 63, v244
    v_and_b32 v6, 8, v1
    v_mfma_f32_32x32x16_bf16 v[32:47], v[76:79], a[108:111], v[32:47]
    v_lshl_add_u32 v4, v6, 3, v4
    s_lshl_b32 s61, s48, 5
    v_xor_b32 v4, s61, v4
    v_lshl_add_u32 v4, v5, 11, v4
    v_add_u32 v248, v4, v27
    v_add_u32 v249, 0x10000, v248
    v_add_u32 v250, 0x20000, v248
    s_barrier
    buffer_load_dwordx4 v229, s[20:23], s68 offen offset:1024 lds
    s_nop 2
    v_pk_fma_f32 v[32:33], v[32:33], s[70:71], v[200:201]
    v_pk_fma_f32 v[34:35], v[34:35], s[70:71], v[200:201]
    v_pk_fma_f32 v[36:37], v[36:37], s[70:71], v[200:201]
    v_pk_fma_f32 v[38:39], v[38:39], s[70:71], v[200:201]
    v_pk_fma_f32 v[40:41], v[40:41], s[70:71], v[200:201]
    v_pk_fma_f32 v[42:43], v[42:43], s[70:71], v[200:201]
    v_pk_fma_f32 v[44:45], v[44:45], s[70:71], v[200:201]
    v_pk_fma_f32 v[46:47], v[46:47], s[70:71], v[200:201]
    v_exp_f32 v202, v32 clamp
    v_exp_f32 v203, v33 clamp
    v_max_f32 v32, v200, v32
    v_max_f32 v33, v200, v33
    v_pk_fma_f32 v[32:33], v[32:33], s[72:73], v[202:203]
    v_exp_f32 v204, v34 clamp
    v_exp_f32 v205, v35 clamp
    v_max_f32 v34, v200, v34
    v_max_f32 v35, v200, v35
    v_pk_fma_f32 v[34:35], v[34:35], s[72:73], v[204:205]
    v_exp_f32 v206, v36 clamp
    buffer_load_dwordx4 v230, s[20:23], s68 offen offset:2048 lds
    v_exp_f32 v207, v37 clamp
    v_max_f32 v36, v200, v36
    v_max_f32 v37, v200, v37
    v_pk_fma_f32 v[36:37], v[36:37], s[72:73], v[206:207]
    v_exp_f32 v208, v38 clamp
    v_exp_f32 v209, v39 clamp
    v_max_f32 v38, v200, v38
    v_max_f32 v39, v200, v39
    v_pk_fma_f32 v[38:39], v[38:39], s[72:73], v[208:209]
    v_exp_f32 v202, v40 clamp
    v_exp_f32 v203, v41 clamp
    v_max_f32 v40, v200, v40
    v_max_f32 v41, v200, v41
    v_pk_fma_f32 v[40:41], v[40:41], s[72:73], v[202:203]
    v_exp_f32 v204, v42 clamp
    v_exp_f32 v205, v43 clamp
    v_max_f32 v42, v200, v42
    v_max_f32 v43, v200, v43
    v_pk_fma_f32 v[42:43], v[42:43], s[72:73], v[204:205]
    buffer_load_dwordx4 v231, s[20:23], s68 offen offset:3072 lds
    s_add_u32 s68, s68, 57344
    v_exp_f32 v206, v44 clamp
    v_exp_f32 v207, v45 clamp
    v_max_f32 v44, v200, v44
    v_max_f32 v45, v200, v45
    v_pk_fma_f32 v[44:45], v[44:45], s[72:73], v[206:207]
    v_exp_f32 v208, v46 clamp
    v_exp_f32 v209, v47 clamp
    v_max_f32 v46, v200, v46
    v_max_f32 v47, v200, v47
    v_pk_fma_f32 v[46:47], v[46:47], s[72:73], v[208:209]
    v_cvt_pk_bf16_f32 v48, v32, v33
    v_cvt_pk_bf16_f32 v49, v34, v35
    v_cvt_pk_bf16_f32 v50, v36, v37
    v_cvt_pk_bf16_f32 v51, v38, v39
    v_cvt_pk_bf16_f32 v52, v40, v41
    v_cvt_pk_bf16_f32 v53, v42, v43
    v_cvt_pk_bf16_f32 v54, v44, v45
    v_cvt_pk_bf16_f32 v55, v46, v47
    buffer_store_dwordx4 v[48:51], v2, s[16:19], s56 offen offset:0 sc1
    buffer_store_dwordx4 v[52:55], v2, s[16:19], s56 offen offset:1024 sc1
    s_add_u32 m0, s6, 32768
    s_nop 0
    buffer_load_dwordx4 v228, s[20:23], s68 offen offset:0 lds
    s_mul_i32 s64, s48, 7
    s_lshr_b32 s64, s64, 1
    s_lshl4_add_u32 s71, s74, s64
    s_lshl_b32 s71, s71, 7
    s_lshl2_add_u32 s64, s49, s48
    s_lshl_b32 s64, s64, 10
    s_add_u32 s64, s64, 261632
    buffer_load_dwordx4 v229, s[20:23], s68 offen offset:1024 lds
    s_sub_u32 s64, s64, s71
    s_add_u32 s71, s71, 1048576
    v_lshlrev_b32 v40, 7, v1
    v_add_u32 v4, s64, v40
    v_cmp_gt_u32 vcc, 4, v1
    s_nop 1
    v_cndmask_b32 v40, v4, v40, vcc
    s_mul_i32 s61, s74, 28672
    buffer_load_dwordx4 v230, s[20:23], s68 offen offset:2048 lds
    s_mul_i32 s63, s48, 7168
    s_add_u32 s70, s61, s63
    s_add_u32 s70, s70, 2097152
    v_and_b32 v4, 31, v1
    v_lshrrev_b32 v5, 5, v1
    v_mul_u32_u24 v6, 896, v4
    v_lshl_add_u32 v6, v5, 4, v6
    buffer_load_dwordx4 v231, s[20:23], s68 offen offset:3072 lds
    s_add_u32 s68, s68, 57344
    s_lshl2_add_u32 s59, s75, s48
    s_min_u32 s64, s59, 13
    s_lshl_b32 s64, s64, 6
    s_add_u32 s61, s61, s64
    buffer_load_dwordx4 v[32:35], v6, s[8:11], s61 offen
    buffer_load_dwordx4 v[36:39], v6, s[8:11], s61 offen offset:32
    v_lshlrev_b32 v4, 4, v4
    s_add_u32 m0, s6, 49152
    s_nop 0
    buffer_load_dwordx4 v228, s[20:23], s68 offen offset:0 lds
    v_add_u32 v4, s63, v4
    v_lshl_add_u32 v24, v5, 3, v4
    v_mul_u32_u24 v5, 504, v5
    v_add3_u32 v25, v5, v4, 8
    s_lshl_b32 s72, s49, 15
    s_lshl1_add_u32 s72, s6, s72
    s_add_u32 s72, s72, 1441792
    buffer_load_dwordx4 v229, s[20:23], s68 offen offset:1024 lds
    s_add_u32 s73, s72, 4096
    s_mul_i32 s58, s74, 14
    s_add_u32 s58, s58, s59
    s_add_u32 s64, s59, 2
    s_lshr_b32 s64, s64, 4
    s_mul_i32 s64, s64, 5120
    s_add_u32 s58, s58, s64
    buffer_load_dwordx4 v230, s[20:23], s68 offen offset:2048 lds
    s_lshl_b32 s58, s58, 11
    s_add_u32 s58, s58, 4194304
    s_lshl4_add_u32 s55, s74, s59
    s_lshl_b32 s55, s55, 8
    s_add_u32 s55, s55, 3932160
    s_add_u32 s67, s70, 3584
    v_bfe_u32 v4, v1, 2, 2
    buffer_load_dwordx4 v231, s[20:23], s68 offen offset:3072 lds
    s_add_u32 s68, s68, 57344
    v_bfe_u32 v5, v1, 4, 1
    v_cmp_eq_u32 vcc, v4, v5
    s_nop 1
    v_cndmask_b32 v28, 0, v28, vcc
    v_mov_b32 v29, v28
    v_mov_b32 v30, v28
    v_mov_b32 v31, v28
    s_waitcnt vmcnt(10)
    s_mov_b64 exec, 1
    buffer_store_dword v28, off, s[16:19], s57 sc1
    s_mov_b64 exec, -1
    s_add_u32 m0, s6, 65536
    s_nop 0
    buffer_load_dwordx4 v228, s[20:23], s68 offen offset:0 lds
    buffer_load_dwordx4 v229, s[20:23], s68 offen offset:1024 lds
    s_barrier
    buffer_load_dwordx4 v230, s[20:23], s68 offen offset:2048 lds
    ds_read_b64_tr_b16 v[128:129], v244 offset:0
    ds_read_b64_tr_b16 v[130:131], v244 offset:1024
    ds_read_b64_tr_b16 v[132:133], v244 offset:4096
    ds_read_b64_tr_b16 v[134:135], v244 offset:5120
    buffer_load_dwordx4 v231, s[20:23], s68 offen offset:3072 lds
    s_add_u32 s68, s68, 57344
    ds_read_b64_tr_b16 v[136:137], v244 offset:8192
    ds_read_b64_tr_b16 v[138:139], v244 offset:9216
    ds_read_b64_tr_b16 v[140:141], v244 offset:12288
    ds_read_b64_tr_b16 v[142:143], v244 offset:13312
    s_add_u32 m0, s6, 81920
    s_nop 0
    buffer_load_dwordx4 v228, s[20:23], s68 offen offset:0 lds
    ds_read_b64_tr_b16 v[144:145], v244 offset:16384
    ds_read_b64_tr_b16 v[146:147], v244 offset:17408
    ds_read_b64_tr_b16 v[148:149], v244 offset:20480
    ds_read_b64_tr_b16 v[150:151], v244 offset:21504
    buffer_load_dwordx4 v229, s[20:23], s68 offen offset:1024 lds
    ds_read_b64_tr_b16 v[152:153], v244 offset:24576
    ds_read_b64_tr_b16 v[154:155], v244 offset:25600
    ds_read_b64_tr_b16 v[156:157], v244 offset:28672
    ds_read_b64_tr_b16 v[158:159], v244 offset:29696
    buffer_load_dwordx4 v230, s[20:23], s68 offen offset:2048 lds
    buffer_load_dwordx4 v231, s[20:23], s68 offen offset:3072 lds
    s_add_u32 s68, s68, 57344
    s_waitcnt vmcnt(9) lgkmcnt(0)
    s_barrier
    s_add_u32 m0, s6, 98304
    s_nop 0
    buffer_load_dwordx4 v228, s[20:23], s68 offen offset:0 lds
    ds_read_b64_tr_b16 v[160:161], v244 offset:32768
    ds_read_b64_tr_b16 v[162:163], v244 offset:33792
    ds_read_b64_tr_b16 v[164:165], v244 offset:36864
    ds_read_b64_tr_b16 v[166:167], v244 offset:37888
    buffer_load_dwordx4 v229, s[20:23], s68 offen offset:1024 lds
    ds_read_b64_tr_b16 v[168:169], v244 offset:40960
    ds_read_b64_tr_b16 v[170:171], v244 offset:41984
    ds_read_b64_tr_b16 v[172:173], v244 offset:45056
    ds_read_b64_tr_b16 v[174:175], v244 offset:46080
    buffer_load_dwordx4 v230, s[20:23], s68 offen offset:2048 lds
    ds_read_b64_tr_b16 v[176:177], v244 offset:49152
    ds_read_b64_tr_b16 v[178:179], v244 offset:50176
    ds_read_b64_tr_b16 v[180:181], v244 offset:53248
    ds_read_b64_tr_b16 v[182:183], v244 offset:54272
    buffer_load_dwordx4 v231, s[20:23], s68 offen offset:3072 lds
    s_add_u32 s68, s68, 57344
    ds_read_b64_tr_b16 v[184:185], v244 offset:57344
    ds_read_b64_tr_b16 v[186:187], v244 offset:58368
    ds_read_b64_tr_b16 v[188:189], v244 offset:61440
    ds_read_b64_tr_b16 v[190:191], v244 offset:62464
    s_mov_b32 exec_lo, 0xfff
    s_mov_b32 exec_hi, 0x0
    s_movk_i32 s66, 0x4000
L_fq_1:
    buffer_load_dword v7, v40, s[16:19], s71 offen sc1
    s_waitcnt vmcnt(0)
    v_cmp_eq_u32 vcc, -1, v7
    s_sub_u32 s66, s66, 1
    s_cbranch_scc1 L_fqd_2
    s_and_b64 exec, vcc, exec
    s_cbranch_scc1 L_fq_1
L_fqd_2:
    s_mov_b64 exec, -1
    buffer_load_dwordx4 a[224:227], v2, s[16:19], s70 offen offset:0 sc1
    buffer_load_dwordx4 a[228:231], v2, s[16:19], s70 offen offset:1024 sc1
    buffer_load_dwordx4 a[232:235], v2, s[16:19], s70 offen offset:1536 sc1
    buffer_load_dwordx4 a[236:239], v2, s[16:19], s70 offen offset:2560 sc1
    buffer_load_dwordx4 a[240:243], v2, s[16:19], s67 offen offset:0 sc1
    buffer_load_dwordx4 a[244:247], v2, s[16:19], s67 offen offset:1024 sc1
    buffer_load_dwordx4 a[248:251], v2, s[16:19], s67 offen offset:1536 sc1
    buffer_load_dwordx4 a[252:255], v2, s[16:19], s67 offen offset:2560 sc1
    buffer_load_dwordx4 v[96:99], v2, s[16:19], s72 offen offset:0 sc1
    buffer_load_dwordx4 v[100:103], v2, s[16:19], s72 offen offset:1024 sc1
    buffer_load_dwordx4 v[104:107], v2, s[16:19], s72 offen offset:2048 sc1
    buffer_load_dwordx4 v[108:111], v2, s[16:19], s72 offen offset:3072 sc1
    buffer_load_dwordx4 v[112:115], v2, s[16:19], s73 offen offset:0 sc1
    buffer_load_dwordx4 v[116:119], v2, s[16:19], s73 offen offset:1024 sc1
    buffer_load_dwordx4 v[120:123], v2, s[16:19], s73 offen offset:2048 sc1
    buffer_load_dwordx4 v[124:127], v2, s[16:19], s73 offen offset:3072 sc1
    s_waitcnt lgkmcnt(0)
    s_barrier
    s_add_u32 m0, s6, 131072
    s_nop 0
    buffer_load_dwordx4 v240, s[24:27], s69 offen offset:0 lds
    ds_read_b64_tr_b16 v[192:193], v245 offset:0
    ds_read_b64_tr_b16 v[194:195], v245 offset:1024
    ds_read_b64_tr_b16 v[196:197], v245 offset:4096
    ds_read_b64_tr_b16 v[198:199], v245 offset:5120
    ds_read_b64_tr_b16 v[200:201], v245 offset:8192
    ds_read_b64_tr_b16 v[202:203], v245 offset:9216
    ds_read_b64_tr_b16 v[204:205], v245 offset:12288
    ds_read_b64_tr_b16 v[206:207], v245 offset:13312
    ds_read_b64_tr_b16 v[208:209], v245 offset:16384
    ds_read_b64_tr_b16 v[210:211], v245 offset:17408
    ds_read_b64_tr_b16 v[212:213], v245 offset:20480
    ds_read_b64_tr_b16 v[214:215], v245 offset:21504
    ds_read_b64_tr_b16 v[216:217], v245 offset:24576
    ds_read_b64_tr_b16 v[218:219], v245 offset:25600
    ds_read_b64_tr_b16 v[220:221], v245 offset:28672
    ds_read_b64_tr_b16 v[222:223], v245 offset:29696
    ds_read_b64_tr_b16 v[224:225], v245 offset:32768
    ds_read_b64_tr_b16 v[226:227], v245 offset:33792
    ds_read_b64_tr_b16 v[228:229], v245 offset:36864
    ds_read_b64_tr_b16 v[230:231], v245 offset:37888
    buffer_load_dwordx4 v241, s[24:27], s69 offen offset:1024 lds
    ds_read_b64_tr_b16 v[232:233], v245 offset:40960
    ds_read_b64_tr_b16 v[234:235], v245 offset:41984
    ds_read_b64_tr_b16 v[236:237], v245 offset:45056
    ds_read_b64_tr_b16 v[238:239], v245 offset:46080
    v_lshlrev_b32 v8, 16, v32
    v_and_b32 v9, s4, v32
    v_lshlrev_b32 v10, 16, v33
    v_and_b32 v11, s4, v33
    v_lshlrev_b32 v12, 16, v34
    v_and_b32 v13, s4, v34
    v_lshlrev_b32 v14, 16, v35
    v_and_b32 v15, s4, v35
    v_lshlrev_b32 v16, 16, v36
    v_and_b32 v17, s4, v36
    v_lshlrev_b32 v18, 16, v37
    v_and_b32 v19, s4, v37
    v_lshlrev_b32 v20, 16, v38
    v_and_b32 v21, s4, v38
    v_lshlrev_b32 v22, 16, v39
    v_and_b32 v23, s4, v39
    s_movk_i32 s66, 0x2000
    s_waitcnt vmcnt(9)
    v_mfma_f32_32x32x16_bf16 v[32:47], v[96:99], a[224:227], 0
    s_add_u32 m0, s6, 133120
    s_nop 0
    buffer_load_dwordx4 v242, s[28:31], s69 offen offset:0 lds
    s_waitcnt vmcnt(9)
    v_mfma_f32_32x32x16_bf16 v[32:47], v[100:103], a[228:231], v[32:47]
    buffer_load_dwordx4 v243, s[28:31], s69 offen offset:1024 lds
    s_add_u32 s69, s69, 229376
    v_max3_u32 v7, v96, v96, v100
    s_waitcnt vmcnt(9)
    v_mfma_f32_32x32x16_bf16 v[48:63], v[104:107], a[232:235], 0
    s_add_u32 m0, s6, 147456
    s_nop 0
    buffer_load_dwordx4 v240, s[24:27], s69 offen offset:0 lds
    s_waitcnt vmcnt(9)
    v_mfma_f32_32x32x16_bf16 v[48:63], v[108:111], a[236:239], v[48:63]
    buffer_load_dwordx4 v241, s[24:27], s69 offen offset:1024 lds
    v_max3_u32 v7, v7, v104, v108
    s_waitcnt vmcnt(9)
    v_mfma_f32_32x32x16_bf16 v[64:79], v[112:115], a[240:243], 0
    s_add_u32 m0, s6, 149504
    s_nop 0
    buffer_load_dwordx4 v242, s[28:31], s69 offen offset:0 lds
    s_waitcnt vmcnt(9)
    v_mfma_f32_32x32x16_bf16 v[64:79], v[116:119], a[244:247], v[64:79]
    buffer_load_dwordx4 v243, s[28:31], s69 offen offset:1024 lds
    s_add_u32 s69, s69, 229376
    v_max3_u32 v7, v7, v112, v116
    s_waitcnt vmcnt(9)
    v_mfma_f32_32x32x16_bf16 v[80:95], v[120:123], a[248:251], 0
    s_add_u32 m0, s6, 114688
    s_nop 0
    buffer_load_dwordx4 v240, s[24:27], s69 offen offset:0 lds
    s_waitcnt vmcnt(9)
    v_mfma_f32_32x32x16_bf16 v[80:95], v[124:127], a[252:255], v[80:95]
    buffer_load_dwordx4 v241, s[24:27], s69 offen offset:1024 lds
    v_max3_u32 v7, v7, v120, v124
    v_cmp_eq_u32 vcc, -1, v7
    s_nop 0
    s_cmp_eq_u64 vcc, 0
    s_cbranch_scc0 L_b_poll
L_b_go:
    v_add_f32 v96, 0x358637bd, v44
    v_rcp_f32 v96, v96
    v_add_f32 v100, 0x358637bd, v60
    v_rcp_f32 v100, v100
    v_add_f32 v104, 0x358637bd, v76
    v_rcp_f32 v104, v104
    v_add_f32 v108, 0x358637bd, v92
    v_rcp_f32 v108, v108
    v_mov_b32 v98, v96
    v_mov_b32 v102, v100
    v_mov_b32 v106, v104
    v_mov_b32 v110, v108
    v_permlane32_swap_b32 v96, v98
    v_permlane32_swap_b32 v100, v102
    v_permlane32_swap_b32 v104, v106
    v_permlane32_swap_b32 v108, v110
    v_pk_mul_f32 v[32:33], v[32:33], v[98:99] op_sel_hi:[1,0]
    v_pk_mul_f32 v[34:35], v[34:35], v[98:99] op_sel_hi:[1,0]
    v_pk_mul_f32 v[36:37], v[36:37], v[98:99] op_sel_hi:[1,0]
    v_pk_mul_f32 v[38:39], v[38:39], v[98:99] op_sel_hi:[1,0]
    v_pk_mul_f32 v[40:41], v[40:41], v[98:99] op_sel_hi:[1,0]
    v_pk_mul_f32 v[42:43], v[42:43], v[98:99] op_sel_hi:[1,0]
    v_pk_mul_f32 v[44:45], v[44:45], v[98:99] op_sel_hi:[1,0]
    v_pk_mul_f32 v[46:47], v[46:47], v[98:99] op_sel_hi:[1,0]
    v_cvt_pk_bf16_f32 v32, v32, v33
    v_cvt_pk_bf16_f32 v33, v34, v35
    v_cvt_pk_bf16_f32 v34, v36, v37
    v_cvt_pk_bf16_f32 v35, v38, v39
    v_cvt_pk_bf16_f32 v36, v40, v41
    v_cvt_pk_bf16_f32 v37, v42, v43
    v_cvt_pk_bf16_f32 v38, v44, v45
    v_cvt_pk_bf16_f32 v39, v46, v47
    ds_write_b64 v24, v[32:33] offset:0
    ds_write_b64 v24, v[34:35] offset:512
    ds_write_b64 v24, v[36:37] offset:1024
    s_mov_b32 exec_hi, 0
    ds_write_b64 v24, v[38:39] offset:1536
    s_mov_b32 exec_hi, -1
    v_pk_mul_f32 v[48:49], v[48:49], v[102:103] op_sel_hi:[1,0]
    v_pk_mul_f32 v[50:51], v[50:51], v[102:103] op_sel_hi:[1,0]
    v_pk_mul_f32 v[52:53], v[52:53], v[102:103] op_sel_hi:[1,0]
    v_pk_mul_f32 v[54:55], v[54:55], v[102:103] op_sel_hi:[1,0]
    v_pk_mul_f32 v[56:57], v[56:57], v[102:103] op_sel_hi:[1,0]
    v_pk_mul_f32 v[58:59], v[58:59], v[102:103] op_sel_hi:[1,0]
    v_pk_mul_f32 v[60:61], v[60:61], v[102:103] op_sel_hi:[1,0]
    v_pk_mul_f32 v[62:63], v[62:63], v[102:103] op_sel_hi:[1,0]
    v_cvt_pk_bf16_f32 v48, v48, v49
    v_cvt_pk_bf16_f32 v49, v50, v51
    v_cvt_pk_bf16_f32 v50, v52, v53
    v_cvt_pk_bf16_f32 v51, v54, v55
    v_cvt_pk_bf16_f32 v52, v56, v57
    v_cvt_pk_bf16_f32 v53, v58, v59
    v_cvt_pk_bf16_f32 v54, v60, v61
    v_cvt_pk_bf16_f32 v55, v62, v63
    ds_write_b64 v25, v[48:49] offset:1536
    ds_write_b64 v25, v[50:51] offset:2048
    ds_write_b64 v25, v[52:53] offset:2560
    s_mov_b32 exec_hi, 0
    ds_write_b64 v25, v[54:55] offset:3072
    s_mov_b32 exec_hi, -1
    v_pk_mul_f32 v[64:65], v[64:65], v[106:107] op_sel_hi:[1,0]
    v_pk_mul_f32 v[66:67], v[66:67], v[106:107] op_sel_hi:[1,0]
    v_pk_mul_f32 v[68:69], v[68:69], v[106:107] op_sel_hi:[1,0]
    v_pk_mul_f32 v[70:71], v[70:71], v[106:107] op_sel_hi:[1,0]
    v_pk_mul_f32 v[72:73], v[72:73], v[106:107] op_sel_hi:[1,0]
    v_pk_mul_f32 v[74:75], v[74:75], v[106:107] op_sel_hi:[1,0]
    v_pk_mul_f32 v[76:77], v[76:77], v[106:107] op_sel_hi:[1,0]
    v_pk_mul_f32 v[78:79], v[78:79], v[106:107] op_sel_hi:[1,0]
    v_cvt_pk_bf16_f32 v64, v64, v65
    v_cvt_pk_bf16_f32 v65, v66, v67
    v_cvt_pk_bf16_f32 v66, v68, v69
    v_cvt_pk_bf16_f32 v67, v70, v71
    v_cvt_pk_bf16_f32 v68, v72, v73
    v_cvt_pk_bf16_f32 v69, v74, v75
    v_cvt_pk_bf16_f32 v70, v76, v77
    v_cvt_pk_bf16_f32 v71, v78, v79
    ds_write_b64 v24, v[64:65] offset:3584
    ds_write_b64 v24, v[66:67] offset:4096
    ds_write_b64 v24, v[68:69] offset:4608
    s_mov_b32 exec_hi, 0
    ds_write_b64 v24, v[70:71] offset:5120
    s_mov_b32 exec_hi, -1
    v_pk_mul_f32 v[80:81], v[80:81], v[110:111] op_sel_hi:[1,0]
    v_pk_mul_f32 v[82:83], v[82:83], v[110:111] op_sel_hi:[1,0]
    v_pk_mul_f32 v[84:85], v[84:85], v[110:111] op_sel_hi:[1,0]
    v_pk_mul_f32 v[86:87], v[86:87], v[110:111] op_sel_hi:[1,0]
    v_pk_mul_f32 v[88:89], v[88:89], v[110:111] op_sel_hi:[1,0]
    v_pk_mul_f32 v[90:91], v[90:91], v[110:111] op_sel_hi:[1,0]
    v_pk_mul_f32 v[92:93], v[92:93], v[110:111] op_sel_hi:[1,0]
    v_pk_mul_f32 v[94:95], v[94:95], v[110:111] op_sel_hi:[1,0]
    v_cvt_pk_bf16_f32 v80, v80, v81
    v_cvt_pk_bf16_f32 v81, v82, v83
    v_cvt_pk_bf16_f32 v82, v84, v85
    v_cvt_pk_bf16_f32 v83, v86, v87
    v_cvt_pk_bf16_f32 v84, v88, v89
    v_cvt_pk_bf16_f32 v85, v90, v91
    v_cvt_pk_bf16_f32 v86, v92, v93
    v_cvt_pk_bf16_f32 v87, v94, v95
    ds_write_b64 v25, v[80:81] offset:5120
    ds_write_b64 v25, v[82:83] offset:5632
    ds_write_b64 v25, v[84:85] offset:6144
    s_mov_b32 exec_hi, 0
    ds_write_b64 v25, v[86:87] offset:6656
    s_mov_b32 exec_hi, -1
    s_waitcnt lgkmcnt(0)
    s_waitcnt vmcnt(6)
    s_barrier
    ds_read_b128 v[64:67], v2 offset:0
    ds_read_b128 v[68:71], v2 offset:1024
    ds_read_b128 v[72:75], v2 offset:2048
    ds_read_b128 v[76:79], v2 offset:3072
    ds_read_b128 v[80:83], v2 offset:4096
    s_waitcnt lgkmcnt(4)
    v_mfma_f32_32x32x16_bf16 v[8:23], v[128:131], v[64:67], v[8:23]
    ds_read_b128 v[84:87], v2 offset:5120
    ds_read_b64_tr_b16 a[0:1], v250 offset:0
    ds_read_b64_tr_b16 a[2:3], v250 offset:512
    s_add_u32 m0, s6, 116736
    s_nop 0
    buffer_load_dwordx4 v242, s[28:31], s69 offen offset:0 lds
    s_waitcnt lgkmcnt(6)
    v_mfma_f32_32x32x16_bf16 v[8:23], v[132:135], v[68:71], v[8:23]
    ds_read_b128 v[64:67], v2 offset:6144
    buffer_load_dwordx4 v243, s[28:31], s69 offen offset:1024 lds
    s_add_u32 s69, s69, 229376
    v_lshrrev_b32 v4, 2, v1
    s_waitcnt lgkmcnt(6)
    v_mfma_f32_32x32x16_bf16 v[8:23], v[136:139], v[72:75], v[8:23]
    ds_read_b128 v[68:71], v2 offset:7168
    v_and_b32 v5, 3, v1
    v_lshlrev_b32 v4, 18, v4
    v_lshl_add_u32 v4, v5, 10, v4
    s_lshl2_add_u32 s62, s76, s48
    s_waitcnt lgkmcnt(6)
    v_mfma_f32_32x32x16_bf16 v[8:23], v[140:143], v[76:79], v[8:23]
    ds_read_b128 v[72:75], v2 offset:8192
    s_add_u32 m0, s6, 49152
    s_nop 0
    buffer_load_dwordx4 v240, s[24:27], s69 offen offset:0 lds
    s_and_b32 s63, s62, 7
    s_waitcnt lgkmcnt(6)
    v_mfma_f32_32x32x16_bf16 v[8:23], v[144:147], v[80:83], v[8:23]
    ds_read_b128 v[76:79], v2 offset:9216
    s_lshr_b32 s64, s62, 3
    s_lshl3_add_u32 s63, s63, s64
    s_lshl_b32 s63, s63, 12
    s_add_u32 s63, s63, 13631488
    s_waitcnt lgkmcnt(6)
    v_mfma_f32_32x32x16_bf16 v[8:23], v[148:151], v[84:87], v[8:23]
    ds_read_b128 v[80:83], v2 offset:10240
    buffer_load_dwordx4 v241, s[24:27], s69 offen offset:1024 lds
    s_lshl_b32 s62, s62, 12
    s_add_u32 s62, s62, 3932160
    s_waitcnt lgkmcnt(4)
    v_mfma_f32_32x32x16_bf16 v[8:23], v[152:155], v[64:67], v[8:23]
    ds_read_b128 v[84:87], v2 offset:11264
    ds_read_b64_tr_b16 a[4:5], v250 offset:4096
    ds_read_b64_tr_b16 a[6:7], v250 offset:4608
    v_add_u32 v24, 57344, v2
    s_waitcnt lgkmcnt(6)
    v_mfma_f32_32x32x16_bf16 v[8:23], v[156:159], v[68:71], v[8:23]
    ds_read_b128 v[64:67], v2 offset:12288
    s_add_u32 m0, s6, 51200
    s_nop 0
    buffer_load_dwordx4 v242, s[28:31], s69 offen offset:0 lds
    v_and_b32 v25, 31, v1
    s_waitcnt lgkmcnt(6)
    v_mfma_f32_32x32x16_bf16 v[8:23], v[160:163], v[72:75], v[8:23]
    ds_read_b128 v[68:71], v2 offset:13312
    v_lshlrev_b32 v25, 4, v25
    v_add_u32 v25, 114688, v25
    s_mul_i32 s68, s48, 7168
    s_mul_i32 s61, s76, 114688
    s_waitcnt lgkmcnt(6)
    v_mfma_f32_32x32x16_bf16 v[8:23], v[164:167], v[76:79], v[8:23]
    ds_read_b128 v[72:75], v2 offset:14336
    buffer_load_dwordx4 v243, s[28:31], s69 offen offset:1024 lds
    s_add_u32 s69, s69, 229376
    s_add_u32 s61, s61, s68
    s_waitcnt lgkmcnt(6)
    v_mfma_f32_32x32x16_bf16 v[8:23], v[168:171], v[80:83], v[8:23]
    ds_read_b128 v[76:79], v2 offset:15360
    s_add_u32 s61, s61, 4194304
    s_mul_i32 s56, s76, 458752
    s_lshl2_add_u32 s56, s68, s56
    s_lshl_b32 s64, s77, 10
    s_waitcnt lgkmcnt(6)
    v_mfma_f32_32x32x16_bf16 v[8:23], v[172:175], v[84:87], v[8:23]
    ds_read_b128 v[80:83], v2 offset:16384
    s_add_u32 m0, s6, 65536
    s_nop 0
    buffer_load_dwordx4 v240, s[24:27], s69 offen offset:0 lds
    s_add_u32 s56, s56, s64
    s_waitcnt lgkmcnt(4)
    v_mfma_f32_32x32x16_bf16 v[8:23], v[176:179], v[64:67], v[8:23]
    ds_read_b128 v[84:87], v2 offset:17408
    s_add_u32 s56, s56, 6291456
    v_add_u32 v6, 1, v1
    v_lshrrev_b32 v6, 3, v6
    v_mad_i32_i24 v5, v6, -7, v1
    s_waitcnt lgkmcnt(4)
    v_mfma_f32_32x32x16_bf16 v[8:23], v[180:183], v[68:71], v[8:23]
    ds_read_b128 v[64:67], v2 offset:18432
    ds_read_b64_tr_b16 a[8:9], v250 offset:8192
    ds_read_b64_tr_b16 a[10:11], v250 offset:8704
    buffer_load_dwordx4 v241, s[24:27], s69 offen offset:1024 lds
    s_waitcnt lgkmcnt(6)
    v_mfma_f32_32x32x16_bf16 v[8:23], v[184:187], v[72:75], v[8:23]
    ds_read_b128 v[68:71], v2 offset:19456
    s_bfe_u32 s64, s78, 0x30002
    v_lshl_add_u32 v5, v5, 3, s64
    v_lshlrev_b32 v6, 1, v6
    v_lshl_add_u32 v6, v5, 3, v6
    s_waitcnt lgkmcnt(6)
    v_mfma_f32_32x32x16_bf16 v[8:23], v[188:191], v[76:79], v[8:23]
    ds_read_b128 v[72:75], v2 offset:20480
    s_add_u32 m0, s6, 67584
    s_nop 0
    buffer_load_dwordx4 v242, s[28:31], s69 offen offset:0 lds
    v_add_u32 v5, 4, v5
    s_waitcnt lgkmcnt(6)
    v_mfma_f32_32x32x16_bf16 v[8:23], v[192:195], v[80:83], v[8:23]
    ds_read_b128 v[76:79], v2 offset:21504
    v_lshrrev_b32 v5, 5, v5
    v_mul_i32_i24 v5, -223, v5
    v_add_lshl_u32 v5, v5, v6, 12
    s_waitcnt lgkmcnt(6)
    v_mfma_f32_32x32x16_bf16 v[8:23], v[196:199], v[84:87], v[8:23]
    ds_read_b128 v[80:83], v2 offset:22528
    buffer_load_dwordx4 v243, s[28:31], s69 offen offset:1024 lds
    s_add_u32 s69, s69, 229376
    v_lshrrev_b32 v48, 3, v1
    s_waitcnt lgkmcnt(6)
    v_mfma_f32_32x32x16_bf16 v[8:23], v[200:203], v[64:67], v[8:23]
    ds_read_b128 v[84:87], v2 offset:23552
    v_and_b32 v47, 7, v1
    s_lshl_b32 s59, s48, 3
    v_add_u32 v48, s59, v48
    v_lshlrev_b32 v118, 9, v47
    s_waitcnt lgkmcnt(4)
    v_mfma_f32_32x32x16_bf16 v[8:23], v[204:207], v[68:71], v[8:23]
    ds_read_b128 v[64:67], v2 offset:24576
    ds_read_b64_tr_b16 a[12:13], v250 offset:12288
    ds_read_b64_tr_b16 a[14:15], v250 offset:12800
    s_add_u32 m0, s6, 81920
    s_nop 0
    buffer_load_dwordx4 v240, s[24:27], s69 offen offset:0 lds
    s_waitcnt lgkmcnt(6)
    v_mfma_f32_32x32x16_bf16 v[8:23], v[208:211], v[72:75], v[8:23]
    ds_read_b128 v[68:71], v2 offset:25600
    v_lshl_add_u32 v118, v48, 4, v118
    v_mul_u32_u24 v117, 896, v48
    v_lshl_add_u32 v117, v47, 4, v117
    v_and_b32 v49, 1, v47
    s_waitcnt lgkmcnt(6)
    v_mfma_f32_32x32x16_bf16 v[8:23], v[212:215], v[76:79], v[8:23]
    ds_read_b128 v[72:75], v2 offset:26624
    buffer_load_dwordx4 v241, s[24:27], s69 offen offset:1024 lds
    v_mul_u32_u24 v116, 576, v49
    s_waitcnt lgkmcnt(6)
    v_mfma_f32_32x32x16_bf16 v[8:23], v[216:219], v[80:83], v[8:23]
    ds_read_b128 v[76:79], v2 offset:27648
    v_lshl_add_u32 v116, v48, 4, v116
    v_lshrrev_b32 v49, 1, v47
    v_mul_u32_u24 v49, 2432, v49
    v_add_u32 v116, v116, v49
    s_waitcnt lgkmcnt(6)
    v_mfma_f32_32x32x16_bf16 v[8:23], v[220:223], v[84:87], v[8:23]
    s_add_u32 m0, s6, 83968
    s_nop 0
    buffer_load_dwordx4 v242, s[28:31], s69 offen offset:0 lds
    v_add_u32 v116, 65536, v116
    s_mul_i32 s59, s48, 9728
    s_waitcnt lgkmcnt(5)
    v_mfma_f32_32x32x16_bf16 v[8:23], v[224:227], v[64:67], v[8:23]
    s_add_u32 s59, s59, 65536
    v_add_u32 v119, s59, v2
    v_and_b32 v49, 32, v1
    v_lshl_add_u32 v119, v49, 1, v119
    s_mul_i32 s70, s78, 28672
    s_waitcnt lgkmcnt(2)
    v_mfma_f32_32x32x16_bf16 v[8:23], v[228:231], v[68:71], v[8:23]
    buffer_load_dwordx4 v243, s[28:31], s69 offen offset:1024 lds
    s_add_u32 s69, s69, 229376
    s_lshl_b32 s71, s80, 12
    s_add_u32 s71, s71, s70
    s_waitcnt lgkmcnt(1)
    v_mfma_f32_32x32x16_bf16 v[8:23], v[232:235], v[72:75], v[8:23]
    s_add_u32 s71, s71, 4194304
    s_lshl_b32 s72, s80, 7
    s_add_u32 s72, s72, s70
    s_lshr_b32 s53, s78, 5
    s_lshl_b32 s53, s53, 2
    s_lshl2_add_u32 s53, s53, s48
    v_mov_b32 v40, 0
    v_mov_b32 v41, 0
    s_waitcnt lgkmcnt(0)
    v_mfma_f32_32x32x16_bf16 v[8:23], v[236:239], v[76:79], v[8:23]
    s_lshl_b32 s53, s53, 10
    s_add_u32 s53, s53, 13631616
    s_lshl2_add_u32 s54, s78, s48
    s_mul_i32 s54, s54, 28672
    s_add_u32 s54, s54, 6291456
    s_add_u32 s73, s56, 344064
    s_nop 5
    v_cvt_pk_bf16_f32 v32, v8, v9
    v_cvt_pk_bf16_f32 v33, v10, v11
    v_cvt_pk_bf16_f32 v34, v12, v13
    v_cvt_pk_bf16_f32 v35, v14, v15
    buffer_store_dwordx4 v[32:35], v2, s[16:19], s58 offen offset:0 sc1
    v_cvt_pk_bf16_f32 v36, v16, v17
    v_cvt_pk_bf16_f32 v37, v18, v19
    v_cvt_pk_bf16_f32 v38, v20, v21
    v_cvt_pk_bf16_f32 v39, v22, v23
    buffer_store_dwordx4 v[36:39], v2, s[16:19], s58 offen offset:1024 sc1
    v_dot2c_f32_bf16 v40, s65, v32
    v_dot2c_f32_bf16 v41, v32, v32
    v_dot2c_f32_bf16 v40, s65, v33
    v_dot2c_f32_bf16 v41, v33, v33
    v_dot2c_f32_bf16 v40, s65, v34
    v_dot2c_f32_bf16 v41, v34, v34
    v_dot2c_f32_bf16 v40, s65, v35
    v_dot2c_f32_bf16 v41, v35, v35
    v_dot2c_f32_bf16 v40, s65, v36
    v_dot2c_f32_bf16 v41, v36, v36
    v_dot2c_f32_bf16 v40, s65, v37
    v_dot2c_f32_bf16 v41, v37, v37
    v_dot2c_f32_bf16 v40, s65, v38
    v_dot2c_f32_bf16 v41, v38, v38
    v_dot2c_f32_bf16 v40, s65, v39
    v_dot2c_f32_bf16 v41, v39, v39
    s_nop 2
    v_permlane32_swap_b32 v40, v41
    v_add_f32 v40, v40, v41
    buffer_store_dword v40, v3, s[16:19], s55 offen sc1
    s_waitcnt vmcnt(7)
    s_barrier
    s_add_u32 m0, s6, 98304
    s_nop 0
    buffer_load_dwordx4 v240, s[24:27], s69 offen offset:0 lds
    ds_read_b64_tr_b16 a[16:17], v250 offset:16384
    ds_read_b64_tr_b16 a[18:19], v250 offset:16896
    ds_read_b64_tr_b16 a[20:21], v250 offset:20480
    ds_read_b64_tr_b16 a[22:23], v250 offset:20992
    ds_read_b64_tr_b16 a[24:25], v250 offset:24576
    ds_read_b64_tr_b16 a[26:27], v250 offset:25088
    ds_read_b64_tr_b16 a[28:29], v250 offset:28672
    ds_read_b64_tr_b16 a[30:31], v250 offset:29184
    ds_read_b64_tr_b16 a[32:33], v249 offset:49152
    ds_read_b64_tr_b16 a[34:35], v249 offset:49664
    ds_read_b64_tr_b16 a[36:37], v249 offset:53248
    buffer_load_dwordx4 v241, s[24:27], s69 offen offset:1024 lds
    ds_read_b64_tr_b16 a[38:39], v249 offset:53760
    ds_read_b64_tr_b16 a[40:41], v249 offset:57344
    ds_read_b64_tr_b16 a[42:43], v249 offset:57856
    ds_read_b64_tr_b16 a[44:45], v249 offset:61440
    ds_read_b64_tr_b16 a[46:47], v249 offset:61952
    ds_read_b64_tr_b16 a[48:49], v248 offset:49152
    ds_read_b64_tr_b16 a[50:51], v248 offset:49664
    ds_read_b64_tr_b16 a[52:53], v248 offset:53248
    ds_read_b64_tr_b16 a[54:55], v248 offset:53760
    ds_read_b64_tr_b16 a[56:57], v248 offset:57344
    s_add_u32 m0, s6, 100352
    s_nop 0
    buffer_load_dwordx4 v242, s[28:31], s69 offen offset:0 lds
    ds_read_b64_tr_b16 a[58:59], v248 offset:57856
    ds_read_b64_tr_b16 a[60:61], v248 offset:61440
    ds_read_b64_tr_b16 a[62:63], v248 offset:61952
    ds_read_b64_tr_b16 a[64:65], v249 offset:0
    ds_read_b64_tr_b16 a[66:67], v249 offset:512
    ds_read_b64_tr_b16 a[68:69], v249 offset:4096
    ds_read_b64_tr_b16 a[70:71], v249 offset:4608
    ds_read_b64_tr_b16 a[72:73], v249 offset:8192
    ds_read_b64_tr_b16 a[74:75], v249 offset:8704
    ds_read_b64_tr_b16 a[76:77], v249 offset:12288
    buffer_load_dwordx4 v243, s[28:31], s69 offen offset:1024 lds
    s_sub_u32 s69, s69, 1376128
    ds_read_b64_tr_b16 a[78:79], v249 offset:12800
    v_mfma_f32_16x16x32_bf16 v[112:115], v[28:31], a[0:3], 0
    v_mfma_f32_16x16x32_bf16 v[112:115], v[28:31], a[4:7], v[112:115]
    v_mfma_f32_16x16x32_bf16 v[112:115], v[28:31], a[8:11], v[112:115]
    v_mfma_f32_16x16x32_bf16 v[112:115], v[28:31], a[12:15], v[112:115]
    v_lshrrev_b32 v44, 3, v1
    v_and_b32 v45, 7, v1
    v_bfe_u32 v46, v1, 4, 1
    v_lshlrev_b32 v46, 2, v46
    v_xor_b32 v46, v46, v45
    s_add_u32 m0, s6, 131072
    s_nop 0
    buffer_load_dwordx4 v240, s[24:27], s69 offen offset:0 lds
    v_mul_u32_u24 v152, 896, v44
    v_lshl_add_u32 v152, v46, 4, v152
    v_add_u32 v153, 6144, v152
    v_add_u32 v154, 112640, v152
    v_add_u32 v155, 118784, v152
    s_mul_i32 s46, s48, 14336
    s_lshl_b32 s64, s80, 7
    s_add_u32 s46, s46, s64
    s_add_u32 s60, s46, 745472
    s_lshl1_add_u32 s47, s6, 118784
    buffer_load_dwordx4 v241, s[24:27], s69 offen offset:1024 lds
    v_and_b32 v44, 1, v1
    v_bfe_u32 v45, v1, 1, 1
    v_lshl_add_u32 v44, v44, 1, v45
    v_bfe_u32 v45, v1, 4, 1
    v_lshl_add_u32 v44, v45, 2, v44
    v_lshlrev_b32 v44, 3, v44
    v_bfe_u32 v45, v1, 3, 1
    v_lshl_add_u32 v44, v45, 6, v44
    v_add_u32 v44, v44, v27
    v_add_u32 v156, s47, v44
    s_add_u32 m0, s6, 133120
    s_nop 0
    buffer_load_dwordx4 v242, s[28:31], s69 offen offset:0 lds
    v_xor_b32 v157, 64, v156
    v_add_u32 v158, s6, v44
    v_xor_b32 v159, 64, v158
    s_mul_i32 s64, s48, 7168
    s_add_u32 s64, s64, 57344
    v_add_u32 v94, s64, v44
    v_xor_b32 v95, 64, v94
    v_bfe_u32 v44, v1, 2, 1
    v_bfe_u32 v45, v1, 3, 1
    v_lshl_add_u32 v44, v44, 1, v45
    buffer_load_dwordx4 v243, s[28:31], s69 offen offset:1024 lds
    s_add_u32 s69, s69, 229376
    v_and_b32 v45, 0x13, v1
    v_lshl_add_u32 v44, v44, 2, v45
    v_and_b32 v45, 16, v1
    v_mad_u32_u24 v44, v45, 3, v44
    v_lshrrev_b32 v45, 5, v1
    v_lshl_add_u32 v44, v45, 26, v44
    v_lshlrev_b32 v92, 2, v44
    s_lshl3_add_u32 s44, s77, s48
    s_lshl_b32 s44, s44, 6
    s_add_u32 s44, s44, 1351680
    s_waitcnt vmcnt(8)
    s_mov_b64 exec, 1
    buffer_store_dword v28, off, s[16:19], s7 sc1
    s_mov_b64 exec, -1
    s_waitcnt vmcnt(5) lgkmcnt(0)
    s_barrier
    s_add_u32 m0, s6, 147456
    s_nop 0
    buffer_load_dwordx4 v240, s[24:27], s69 offen offset:0 lds
    ds_read_b64_tr_b16 a[80:81], v249 offset:16384
    ds_read_b64_tr_b16 a[82:83], v249 offset:16896
    ds_read_b64_tr_b16 a[84:85], v249 offset:20480
    ds_read_b64_tr_b16 a[86:87], v249 offset:20992
    buffer_load_dwordx4 v241, s[24:27], s69 offen offset:1024 lds
    ds_read_b64_tr_b16 a[88:89], v249 offset:24576
    ds_read_b64_tr_b16 a[90:91], v249 offset:25088
    ds_read_b64_tr_b16 a[92:93], v249 offset:28672
    ds_read_b64_tr_b16 a[94:95], v249 offset:29184
    s_add_u32 m0, s6, 149504
    s_nop 0
    buffer_load_dwordx4 v242, s[28:31], s69 offen offset:0 lds
    ds_read_b64_tr_b16 a[96:97], v249 offset:32768
    ds_read_b64_tr_b16 a[98:99], v249 offset:33280
    ds_read_b64_tr_b16 a[100:101], v249 offset:36864
    ds_read_b64_tr_b16 a[102:103], v249 offset:37376
    buffer_load_dwordx4 v243, s[28:31], s69 offen offset:1024 lds
    s_add_u32 s69, s69, 229376
    ds_read_b64_tr_b16 a[104:105], v249 offset:40960
    ds_read_b64_tr_b16 a[106:107], v249 offset:41472
    ds_read_b64_tr_b16 a[108:109], v249 offset:45056
    ds_read_b64_tr_b16 a[110:111], v249 offset:45568
    s_add_u32 m0, s6, 32768
    s_nop 0
    buffer_load_dwordx4 v240, s[24:27], s69 offen offset:0 lds
    v_mfma_f32_16x16x32_bf16 v[112:115], v[28:31], a[16:19], v[112:115]
    v_mfma_f32_16x16x32_bf16 v[112:115], v[28:31], a[20:23], v[112:115]
    v_mfma_f32_16x16x32_bf16 v[112:115], v[28:31], a[24:27], v[112:115]
    v_mfma_f32_16x16x32_bf16 v[112:115], v[28:31], a[28:31], v[112:115]
    buffer_load_dwordx4 v241, s[24:27], s69 offen offset:1024 lds
    v_mfma_f32_16x16x32_bf16 v[112:115], v[28:31], a[32:35], v[112:115]
    v_mfma_f32_16x16x32_bf16 v[112:115], v[28:31], a[36:39], v[112:115]
    v_mfma_f32_16x16x32_bf16 v[112:115], v[28:31], a[40:43], v[112:115]
    v_mfma_f32_16x16x32_bf16 v[112:115], v[28:31], a[44:47], v[112:115]
    s_add_u32 m0, s6, 34816
    s_nop 0
    buffer_load_dwordx4 v242, s[28:31], s69 offen offset:0 lds
    v_mfma_f32_16x16x32_bf16 v[112:115], v[28:31], a[48:51], v[112:115]
    v_mfma_f32_16x16x32_bf16 v[112:115], v[28:31], a[52:55], v[112:115]
    v_mfma_f32_16x16x32_bf16 v[112:115], v[28:31], a[56:59], v[112:115]
    v_mfma_f32_16x16x32_bf16 v[112:115], v[28:31], a[60:63], v[112:115]
    buffer_load_dwordx4 v243, s[28:31], s69 offen offset:1024 lds
    s_add_u32 s69, s69, 229376
    v_mfma_f32_16x16x32_bf16 v[112:115], v[28:31], a[64:67], v[112:115]
    v_mfma_f32_16x16x32_bf16 v[112:115], v[28:31], a[68:71], v[112:115]
    v_mfma_f32_16x16x32_bf16 v[112:115], v[28:31], a[72:75], v[112:115]
    v_mfma_f32_16x16x32_bf16 v[112:115], v[28:31], a[76:79], v[112:115]
    s_waitcnt vmcnt(4) lgkmcnt(0)
    s_barrier
    s_mov_b64 exec, 0x3fff
    buffer_load_dword v43, v4, s[16:19], s63 offen sc1
    s_mov_b64 exec, -1
    v_mfma_f32_16x16x32_bf16 v[112:115], v[28:31], a[80:83], v[112:115]
    s_add_u32 m0, s6, 49152
    s_nop 0
    buffer_load_dwordx4 v240, s[24:27], s69 offen offset:0 lds
    v_mfma_f32_16x16x32_bf16 v[112:115], v[28:31], a[84:87], v[112:115]
    buffer_load_dwordx4 v241, s[24:27], s69 offen offset:1024 lds
    v_mfma_f32_16x16x32_bf16 v[112:115], v[28:31], a[88:91], v[112:115]
    s_add_u32 m0, s6, 51200
    s_nop 0
    buffer_load_dwordx4 v242, s[28:31], s69 offen offset:0 lds
    v_mfma_f32_16x16x32_bf16 v[112:115], v[28:31], a[92:95], v[112:115]
    buffer_load_dwordx4 v243, s[28:31], s69 offen offset:1024 lds
    s_add_u32 s69, s69, 229376
    v_mfma_f32_16x16x32_bf16 v[112:115], v[28:31], a[96:99], v[112:115]
    s_add_u32 m0, s6, 65536
    s_nop 0
    buffer_load_dwordx4 v240, s[24:27], s69 offen offset:0 lds
    v_mfma_f32_16x16x32_bf16 v[112:115], v[28:31], a[100:103], v[112:115]
    buffer_load_dwordx4 v241, s[24:27], s69 offen offset:1024 lds
    v_mfma_f32_16x16x32_bf16 v[112:115], v[28:31], a[104:107], v[112:115]
    s_add_u32 m0, s6, 67584
    s_nop 0
    buffer_load_dwordx4 v242, s[28:31], s69 offen offset:0 lds
    v_mfma_f32_16x16x32_bf16 v[112:115], v[28:31], a[108:111], v[112:115]
    buffer_load_dwordx4 v243, s[28:31], s69 offen offset:1024 lds
    s_add_u32 s69, s69, 229376
    s_movk_i32 s66, 0x4000
    s_waitcnt vmcnt(8)
    v_cmp_eq_u32 vcc, -1, v43
    s_nop 0
    s_and_b32 vcc_lo, vcc_lo, 0x3fff
    s_cbranch_scc1 L_fha_no
L_fha_ok:
    s_barrier
    s_add_u32 m0, s68, 0
    s_nop 0
    buffer_load_dwordx4 v2, s[16:19], s61 offen offset:0 sc1 lds
    buffer_load_dwordx4 v2, s[16:19], s61 offen offset:1024 sc1 lds
    buffer_load_dwordx4 v2, s[16:19], s61 offen offset:2048 sc1 lds
    buffer_load_dwordx4 v2, s[16:19], s61 offen offset:3072 sc1 lds
    s_addk_i32 s61, 4096
    s_add_u32 m0, s68, 4096
    s_nop 0
    buffer_load_dwordx4 v2, s[16:19], s61 offen offset:0 sc1 lds
    buffer_load_dwordx4 v2, s[16:19], s61 offen offset:1024 sc1 lds
    buffer_load_dwordx4 v2, s[16:19], s61 offen offset:2048 sc1 lds
    s_addk_i32 s61, 24576
    buffer_load_dword v64, v3, s[16:19], s62 offen offset:0 sc1
    ds_read_b64_tr_b16 a[112:113], v250 offset:0
    ds_read_b64_tr_b16 a[114:115], v250 offset:512
    ds_read_b64_tr_b16 a[116:117], v250 offset:4096
    buffer_load_dword v65, v3, s[16:19], s62 offen offset:256 sc1
    ds_read_b64_tr_b16 a[118:119], v250 offset:4608
    ds_read_b64_tr_b16 a[120:121], v250 offset:8192
    ds_read_b64_tr_b16 a[122:123], v250 offset:8704
    buffer_load_dword v66, v3, s[16:19], s62 offen offset:512 sc1
    ds_read_b64_tr_b16 a[124:125], v250 offset:12288
    ds_read_b64_tr_b16 a[126:127], v250 offset:12800
    ds_read_b64_tr_b16 a[128:129], v250 offset:16384
    buffer_load_dword v67, v3, s[16:19], s62 offen offset:768 sc1
    ds_read_b64_tr_b16 a[130:131], v250 offset:16896
    ds_read_b64_tr_b16 a[132:133], v250 offset:20480
    ds_read_b64_tr_b16 a[134:135], v250 offset:20992
    buffer_load_dword v68, v3, s[16:19], s62 offen offset:1024 sc1
    ds_read_b64_tr_b16 a[136:137], v250 offset:24576
    ds_read_b64_tr_b16 a[138:139], v250 offset:25088
    ds_read_b64_tr_b16 a[140:141], v250 offset:28672
    buffer_load_dword v69, v3, s[16:19], s62 offen offset:1280 sc1
    ds_read_b64_tr_b16 a[142:143], v250 offset:29184
    ds_read_b64_tr_b16 a[144:145], v248 offset:32768
    ds_read_b64_tr_b16 a[146:147], v248 offset:33280
    buffer_load_dword v70, v3, s[16:19], s62 offen offset:1536 sc1
    ds_read_b64_tr_b16 a[148:149], v248 offset:36864
    ds_read_b64_tr_b16 a[150:151], v248 offset:37376
    buffer_load_dword v71, v3, s[16:19], s62 offen offset:1792 sc1
    ds_read_b64_tr_b16 a[152:153], v248 offset:40960
    ds_read_b64_tr_b16 a[154:155], v248 offset:41472
    ds_read_b64_tr_b16 a[156:157], v248 offset:45056
    buffer_load_dword v72, v3, s[16:19], s62 offen offset:2048 sc1
    ds_read_b64_tr_b16 a[158:159], v248 offset:45568
    v_mov_b32 v98, 0
    v_mov_b32 v99, 0
    buffer_load_dword v73, v3, s[16:19], s62 offen offset:2304 sc1
    v_mov_b32 v102, 0
    v_mov_b32 v103, 0
    v_mov_b32 v106, 0
    buffer_load_dword v74, v3, s[16:19], s62 offen offset:2560 sc1
    v_mov_b32 v107, 0
    v_mov_b32 v110, 0
    v_mov_b32 v111, 0
    buffer_load_dword v75, v3, s[16:19], s62 offen offset:2816 sc1
    v_cvt_pk_bf16_f32 v96, v112, v112
    v_and_b32 v97, s4, v96
    v_sub_f32 v97, v112, v97
    buffer_load_dword v76, v3, s[16:19], s62 offen offset:3072 sc1
    v_cvt_pk_bf16_f32 v97, v97, v98
    v_mov_b32 v112, -1
    v_mov_b32 v113, -1
    buffer_load_dword v77, v3, s[16:19], s62 offen offset:3328 sc1
    v_mov_b32 v114, -1
    v_mov_b32 v115, -1
    s_add_u32 m0, s6, 81920
    s_nop 0
    buffer_load_dwordx4 v240, s[24:27], s69 offen offset:0 lds
    buffer_load_dwordx4 v241, s[24:27], s69 offen offset:1024 lds
    s_add_u32 m0, s6, 83968
    s_nop 0
    buffer_load_dwordx4 v242, s[28:31], s69 offen offset:0 lds
    buffer_load_dwordx4 v243, s[28:31], s69 offen offset:1024 lds
    s_add_u32 s69, s69, 229376
    s_waitcnt vmcnt(18)
    s_waitcnt lgkmcnt(0)
    s_barrier
    ds_read_b128 v[120:123], v2 offset:0
    ds_read_b128 v[124:127], v2 offset:1024
    ds_read_b128 v[128:131], v2 offset:2048
    ds_read_b128 v[132:135], v2 offset:3072
    ds_read_b128 v[136:139], v2 offset:4096
    ds_read_b128 v[140:143], v2 offset:5120
    ds_read_b128 v[144:147], v2 offset:6144
    s_waitcnt lgkmcnt(6)
    v_mfma_f32_32x32x16_bf16 v[32:47], a[0:3], v[120:123], 0
    ds_read_b128 v[148:151], v2 offset:7168
    ds_read_b64_tr_b16 a[160:161], v248 offset:49152
    ds_read_b64_tr_b16 a[162:163], v248 offset:49664
    s_add_u32 m0, s6, 98304
    s_waitcnt lgkmcnt(8)
    v_mfma_f32_32x32x16_bf16 v[32:47], a[4:7], v[124:127], v[32:47]
    ds_read_b128 v[120:123], v2 offset:8192
    buffer_load_dwordx4 v240, s[24:27], s69 offen offset:0 lds
    ds_read_b64_tr_b16 a[164:165], v248 offset:53248
    s_waitcnt lgkmcnt(9)
    v_mfma_f32_32x32x16_bf16 v[32:47], a[8:11], v[128:131], v[32:47]
    ds_read_b128 v[124:127], v2 offset:9216
    ds_read_b64_tr_b16 a[166:167], v248 offset:53760
    s_waitcnt lgkmcnt(8)
    v_mfma_f32_32x32x16_bf16 v[32:47], a[12:15], v[132:135], v[32:47]
    ds_read_b128 v[128:131], v2 offset:10240
    buffer_load_dwordx4 v241, s[24:27], s69 offen offset:1024 lds
    ds_read_b64_tr_b16 a[168:169], v248 offset:57344
    ds_read_b64_tr_b16 a[170:171], v248 offset:57856
    v_mfma_f32_32x32x16_bf16 v[32:47], a[16:19], v[136:139], v[32:47]
    ds_read_b128 v[132:135], v2 offset:11264
    ds_read_b64_tr_b16 a[172:173], v248 offset:61440
    s_add_u32 m0, s6, 100352
    v_mfma_f32_32x32x16_bf16 v[32:47], a[20:23], v[140:143], v[32:47]
    ds_read_b128 v[136:139], v2 offset:12288
    buffer_load_dwordx4 v242, s[28:31], s69 offen offset:0 lds
    ds_read_b64_tr_b16 a[174:175], v248 offset:61952
    s_waitcnt lgkmcnt(10)
    v_mfma_f32_32x32x16_bf16 v[32:47], a[24:27], v[144:147], v[32:47]
    ds_read_b128 v[140:143], v2 offset:13312
    ds_read_b64_tr_b16 a[176:177], v249 offset:0
    ds_read_b64_tr_b16 a[178:179], v249 offset:512
    v_mfma_f32_32x32x16_bf16 v[32:47], a[28:31], v[148:151], v[32:47]
    ds_read_b128 v[144:147], v2 offset:14336
    buffer_load_dwordx4 v243, s[28:31], s69 offen offset:1024 lds
    s_add_u32 s69, s69, 229376
    ds_read_b64_tr_b16 a[180:181], v249 offset:4096
    v_mfma_f32_32x32x16_bf16 v[32:47], a[32:35], v[120:123], v[32:47]
    s_waitcnt lgkmcnt(5)
    s_barrier
    ds_read_b128 v[148:151], v2 offset:15360
    ds_read_b64_tr_b16 a[182:183], v249 offset:4608
    s_add_u32 m0, s47, 0
    v_mfma_f32_32x32x16_bf16 v[32:47], a[36:39], v[124:127], v[32:47]
    ds_read_b128 v[120:123], v2 offset:16384
    ds_read_b64_tr_b16 a[184:185], v249 offset:8192
    ds_read_b64_tr_b16 a[186:187], v249 offset:8704
    buffer_load_dwordx4 v152, s[32:35], s46 offen offset:0 lds
    v_mfma_f32_32x32x16_bf16 v[32:47], a[40:43], v[128:131], v[32:47]
    ds_read_b128 v[124:127], v2 offset:17408
    ds_read_b64_tr_b16 a[188:189], v249 offset:12288
    s_waitcnt vmcnt(9)
    v_add_f32 v64, v64, v65
    v_add_f32 v64, v64, v66
    v_add_f32 v64, v64, v67
    v_mfma_f32_32x32x16_bf16 v[32:47], a[44:47], v[132:135], v[32:47]
    ds_read_b128 v[128:131], v2 offset:18432
    ds_read_b64_tr_b16 a[190:191], v249 offset:12800
    buffer_load_dwordx4 v153, s[32:35], s46 offen offset:1024 lds
    s_waitcnt lgkmcnt(10)
    v_mfma_f32_32x32x16_bf16 v[32:47], a[48:51], v[136:139], v[32:47]
    ds_read_b128 v[132:135], v2 offset:19456
    v_add_f32 v64, v64, v68
    v_add_f32 v64, v64, v69
    v_add_f32 v64, v64, v70
    v_add_f32 v64, v64, v71
    v_add_f32 v64, v64, v72
    v_mfma_f32_32x32x16_bf16 v[32:47], a[52:55], v[140:143], v[32:47]
    ds_read_b128 v[136:139], v2 offset:20480
    buffer_load_dwordx4 v154, s[32:35], s46 offen offset:2048 lds
    v_add_f32 v64, v64, v73
    v_add_f32 v64, v64, v74
    v_add_f32 v64, v64, v75
    v_mfma_f32_32x32x16_bf16 v[32:47], a[56:59], v[144:147], v[32:47]
    ds_read_b128 v[140:143], v2 offset:21504
    v_add_f32 v64, v64, v76
    v_add_f32 v64, v64, v77
    v_mul_f32 v64, 0x3b124925, v64
    v_mov_b32 v65, v64
    s_waitcnt lgkmcnt(6)
    v_mfma_f32_32x32x16_bf16 v[32:47], a[60:63], v[148:151], v[32:47]
    ds_read_b128 v[144:147], v2 offset:22528
    buffer_load_dwordx4 v155, s[32:35], s46 offen offset:3072 lds
    s_add_u32 s46, s46, 229376
    v_permlane32_swap_b32 v64, v65
    v_fma_f32 v65, -v64, v64, v65
    v_mfma_f32_32x32x16_bf16 v[32:47], a[64:67], v[120:123], v[32:47]
    ds_read_b128 v[148:151], v2 offset:23552
    v_max_f32 v65, 0, v65
    v_add_f32 v71, 0x3727c5ac, v65
    v_rsq_f32 v65, v71
    v_sub_f32 v68, 0, v64
    s_add_u32 m0, s68, 28672
    v_mfma_f32_32x32x16_bf16 v[32:47], a[68:71], v[124:127], v[32:47]
    ds_read_b128 v[120:123], v2 offset:24576
    buffer_load_dwordx4 v2, s[16:19], s61 offen offset:0 sc1 lds
    v_mul_f32 v69, 0xc0135761, v65
    v_mul_f32 v65, v65, v65
    s_waitcnt lgkmcnt(4)
    v_mfma_f32_32x32x16_bf16 v[32:47], a[72:75], v[128:131], v[32:47]
    ds_read_b128 v[124:127], v2 offset:25600
    v_mul_f32 v65, 0x3d372713, v65
    v_mul_f32 v70, v65, v69
    v_cvt_pk_bf16_f32 v73, v68, v68
    v_and_b32 v72, s4, v73
    v_sub_f32 v72, v68, v72
    v_mfma_f32_32x32x16_bf16 v[32:47], a[76:79], v[132:135], v[32:47]
    ds_read_b128 v[128:131], v2 offset:26624
    buffer_load_dwordx4 v2, s[16:19], s61 offen offset:1024 sc1 lds
    v_cvt_pk_bf16_f32 v72, v68, v72
    s_lshr_b32 s63, s5, 2
    v_add_u32 v64, s63, v25
    v_mfma_f32_32x32x16_bf16 v[32:47], a[80:83], v[136:139], v[32:47]
    ds_read_b128 v[132:135], v2 offset:27648
    ds_write_b128 v64, v[68:71]
    ds_write_b64 v64, v[72:73] offset:2048
    s_waitcnt lgkmcnt(6)
    v_mfma_f32_32x32x16_bf16 v[32:47], a[84:87], v[140:143], v[32:47]
    ds_read_b128 v[136:139], v2 offset:0
    buffer_load_dwordx4 v2, s[16:19], s61 offen offset:2048 sc1 lds
    v_mfma_f32_32x32x16_bf16 v[32:47], a[88:91], v[144:147], v[32:47]
    ds_read_b128 v[140:143], v2 offset:1024
    v_mfma_f32_32x32x16_bf16 v[32:47], a[92:95], v[148:151], v[32:47]
    s_waitcnt vmcnt(7) lgkmcnt(2)
    s_barrier
    ds_read_b128 v[144:147], v2 offset:2048
    ds_read_b64_tr_b16 a[192:193], v249 offset:16384
    ds_read_b64_tr_b16 a[194:195], v249 offset:16896
    buffer_load_dwordx4 v2, s[16:19], s61 offen offset:3072 sc1 lds
    s_addk_i32 s61, 4096
    v_mfma_f32_32x32x16_bf16 v[32:47], a[96:99], v[120:123], v[32:47]
    ds_read_b128 v[148:151], v2 offset:3072
    ds_read_b64_tr_b16 a[196:197], v249 offset:20480
    ds_read_b128 v[8:11], v25 offset:0
    ds_read_b64 v[104:105], v25 offset:2048
    s_add_u32 m0, s68, 32768
    v_mfma_f32_32x32x16_bf16 v[32:47], a[100:103], v[124:127], v[32:47]
    ds_read_b128 v[120:123], v2 offset:4096
    ds_read_b64_tr_b16 a[198:199], v249 offset:20992
    buffer_load_dwordx4 v2, s[16:19], s61 offen offset:0 sc1 lds
    v_mfma_f32_32x32x16_bf16 v[32:47], a[104:107], v[128:131], v[32:47]
    ds_read_b128 v[124:127], v2 offset:5120
    ds_read_b64_tr_b16 a[200:201], v249 offset:24576
    ds_read_b64_tr_b16 a[202:203], v249 offset:25088
    s_waitcnt lgkmcnt(12)
    v_mfma_f32_32x32x16_bf16 v[32:47], a[108:111], v[132:135], v[32:47]
    ds_read_b128 v[128:131], v2 offset:6144
    ds_read_b64_tr_b16 a[204:205], v249 offset:28672
    buffer_load_dwordx4 v2, s[16:19], s61 offen offset:1024 sc1 lds
    s_waitcnt lgkmcnt(7)
    v_mfma_f32_32x32x16_bf16 v[32:47], v[96:99], v[104:107], v[32:47]
    ds_read_b64_tr_b16 a[206:207], v249 offset:29184
    v_mfma_f32_32x32x16_bf16 v[48:63], a[112:115], v[136:139], 0
    ds_read_b128 v[132:135], v2 offset:7168
    ds_read_b64_tr_b16 a[208:209], v249 offset:32768
    ds_read_b64_tr_b16 a[210:211], v249 offset:33280
    buffer_load_dwordx4 v2, s[16:19], s61 offen offset:2048 sc1 lds
    s_addk_i32 s61, 24576
    v_mfma_f32_32x32x16_bf16 v[48:63], a[116:119], v[140:143], v[48:63]
    ds_read_b128 v[136:139], v2 offset:8192
    ds_read_b64_tr_b16 a[212:213], v249 offset:36864
    buffer_load_dword v88, v92, s[16:19], s44 offen sc1
    s_waitcnt lgkmcnt(12)
    s_add_u32 m0, s47, 4096
    v_mfma_f32_32x32x16_bf16 v[48:63], a[120:123], v[144:147], v[48:63]
    ds_read_b128 v[140:143], v2 offset:9216
    ds_read_b64_tr_b16 a[214:215], v249 offset:37376
    buffer_load_dwordx4 v152, s[32:35], s46 offen offset:0 lds
    v_mul_f32 v80, v32, v32
    v_mul_f32 v81, v33, v33
    v_mfma_f32_32x32x16_bf16 v[48:63], a[124:127], v[148:151], v[48:63]
    ds_read_b128 v[144:147], v2 offset:10240
    ds_read_b64_tr_b16 a[216:217], v249 offset:40960
    ds_read_b64_tr_b16 a[218:219], v249 offset:41472
    v_mul_f32 v82, v34, v34
    v_mul_f32 v83, v35, v35
    v_fma_f32 v80, v80, v10, v9
    v_mfma_f32_32x32x16_bf16 v[48:63], a[128:131], v[120:123], v[48:63]
    ds_read_b128 v[148:151], v2 offset:11264
    ds_read_b64_tr_b16 a[220:221], v249 offset:45056
    buffer_load_dwordx4 v153, s[32:35], s46 offen offset:1024 lds
    v_fma_f32 v81, v81, v10, v9
    s_waitcnt lgkmcnt(11)
    v_mfma_f32_32x32x16_bf16 v[48:63], a[132:135], v[124:127], v[48:63]
    ds_read_b128 v[120:123], v2 offset:12288
    ds_read_b64_tr_b16 a[222:223], v249 offset:45568
    v_fma_f32 v82, v82, v10, v9
    v_fma_f32 v83, v83, v10, v9
    v_mul_f32 v80, v80, v32
    v_mul_f32 v81, v81, v33
    v_mfma_f32_32x32x16_bf16 v[48:63], a[136:139], v[128:131], v[48:63]
    ds_read_b128 v[124:127], v2 offset:13312
    buffer_load_dwordx4 v154, s[32:35], s46 offen offset:2048 lds
    v_mul_f32 v82, v82, v34
    v_mul_f32 v83, v83, v35
    v_exp_f32 v80, v80
    v_mfma_f32_32x32x16_bf16 v[48:63], a[140:143], v[132:135], v[48:63]
    ds_read_b128 v[128:131], v2 offset:14336
    v_mul_f32 v32, v32, v40
    v_exp_f32 v81, v81
    v_mul_f32 v33, v33, v41
    s_waitcnt lgkmcnt(8)
    v_mfma_f32_32x32x16_bf16 v[48:63], a[144:147], v[136:139], v[48:63]
    ds_read_b128 v[132:135], v2 offset:15360
    s_waitcnt vmcnt(13)
    ds_read_b64_tr_b16 v[160:161], v156 offset:0
    buffer_load_dwordx4 v155, s[32:35], s46 offen offset:3072 lds
    s_add_u32 s46, s46, 229376
    v_exp_f32 v82, v82
    v_mfma_f32_32x32x16_bf16 v[48:63], a[148:151], v[140:143], v[48:63]
    s_waitcnt lgkmcnt(4)
    s_barrier
    ds_read_b128 v[136:139], v2 offset:16384
    ds_read_b64_tr_b16 v[162:163], v156 offset:512
    v_mul_f32 v34, v34, v42
    v_mfma_f32_32x32x16_bf16 v[48:63], a[152:155], v[144:147], v[48:63]
    ds_read_b128 v[140:143], v2 offset:17408
    ds_read_b64_tr_b16 v[164:165], v157 offset:0
    v_exp_f32 v83, v83
    v_mul_f32 v35, v35, v43
    s_waitcnt lgkmcnt(7)
    s_add_u32 m0, s68, 86016
    v_mfma_f32_32x32x16_bf16 v[48:63], a[156:159], v[148:151], v[48:63]
    ds_read_b128 v[144:147], v2 offset:18432
    ds_read_b64_tr_b16 v[166:167], v157 offset:512
    buffer_load_dwordx4 v152, s[32:35], s46 offen offset:0 lds
    v_fma_f32 v80, v80, v11, v11
    v_fma_f32 v81, v81, v11, v11
    v_mfma_f32_32x32x16_bf16 v[48:63], a[160:163], v[120:123], v[48:63]
    ds_read_b128 v[148:151], v2 offset:19456
    s_waitcnt vmcnt(13)
    ds_read_b64_tr_b16 v[168:169], v156 offset:2048
    v_fma_f32 v82, v82, v11, v11
    v_fma_f32 v83, v83, v11, v11
    v_rcp_f32 v80, v80
    v_mfma_f32_32x32x16_bf16 v[48:63], a[164:167], v[124:127], v[48:63]
    ds_read_b128 v[120:123], v2 offset:20480
    ds_read_b64_tr_b16 v[170:171], v156 offset:2560
    buffer_load_dwordx4 v153, s[32:35], s46 offen offset:1024 lds
    s_waitcnt lgkmcnt(9)
    v_mfma_f32_32x32x16_bf16 v[48:63], a[168:171], v[128:131], v[48:63]
    ds_read_b128 v[124:127], v2 offset:21504
    ds_read_b64_tr_b16 v[172:173], v157 offset:2048
    v_rcp_f32 v81, v81
    v_mul_f32 v32, v32, v80
    v_rcp_f32 v82, v82
    v_mfma_f32_32x32x16_bf16 v[48:63], a[172:175], v[132:135], v[48:63]
    ds_read_b128 v[128:131], v2 offset:22528
    ds_read_b64_tr_b16 v[174:175], v157 offset:2560
    buffer_load_dwordx4 v154, s[32:35], s46 offen offset:2048 lds
    v_mul_f32 v33, v33, v81
    v_rcp_f32 v83, v83
    v_mfma_f32_32x32x16_bf16 v[48:63], a[176:179], v[136:139], v[48:63]
    ds_read_b128 v[132:135], v2 offset:23552
    v_mul_f32 v34, v34, v82
    v_cvt_pk_bf16_f32 v16, v32, v33
    v_mul_f32 v35, v35, v83
    v_cvt_pk_bf16_f32 v17, v34, v35
    s_waitcnt lgkmcnt(8)
    v_mfma_f32_32x32x16_bf16 v[48:63], a[180:183], v[140:143], v[48:63]
    ds_read_b128 v[136:139], v2 offset:24576
    buffer_load_dwordx4 v155, s[32:35], s46 offen offset:3072 lds
    s_add_u32 s46, s46, 229376
    v_mul_f32 v84, v36, v36
    v_mul_f32 v85, v37, v37
    v_mul_f32 v86, v38, v38
    v_mfma_f32_32x32x16_bf16 v[48:63], a[184:187], v[144:147], v[48:63]
    ds_read_b128 v[140:143], v2 offset:25600
    v_mul_f32 v87, v39, v39
    v_fma_f32 v84, v84, v10, v9
    v_fma_f32 v85, v85, v10, v9
    v_fma_f32 v86, v86, v10, v9
    s_add_u32 m0, s68, 57344
    v_mfma_f32_32x32x16_bf16 v[48:63], a[188:191], v[148:151], v[48:63]
    ds_read_b128 v[144:147], v2 offset:26624
    buffer_load_dwordx4 v2, s[16:19], s61 offen offset:0 sc1 lds
    v_fma_f32 v87, v87, v10, v9
    v_mul_f32 v84, v84, v36
    v_mul_f32 v85, v85, v37
    s_waitcnt lgkmcnt(5)
    v_mfma_f32_32x32x16_bf16 v[48:63], a[192:195], v[120:123], v[48:63]
    ds_read_b128 v[148:151], v2 offset:27648
    v_mul_f32 v86, v86, v38
    v_mul_f32 v87, v87, v39
    v_exp_f32 v84, v84
    v_mul_f32 v36, v36, v44
    v_mfma_f32_32x32x16_bf16 v[48:63], a[196:199], v[124:127], v[48:63]
    s_waitcnt vmcnt(10)
    s_barrier
    ds_read_b128 v[120:123], v2 offset:28672
    buffer_load_dwordx4 v2, s[16:19], s61 offen offset:1024 sc1 lds
    v_exp_f32 v85, v85
    s_waitcnt vmcnt(10)
    v_cmp_eq_u32 vcc, -1, v88
    v_mfma_f32_32x32x16_bf16 v[48:63], a[200:203], v[128:131], v[48:63]
    ds_read_b128 v[124:127], v2 offset:29696
    s_cmp_lg_u64 vcc, 0
    s_cbranch_scc1 L_cs1_no
L_cs1_ok:
    v_mul_f32 v37, v37, v45
    v_exp_f32 v86, v86
    s_waitcnt lgkmcnt(4)
    v_mfma_f32_32x32x16_bf16 v[48:63], a[204:207], v[132:135], v[48:63]
    ds_read_b128 v[128:131], v2 offset:30720
    buffer_load_dwordx4 v2, s[16:19], s61 offen offset:2048 sc1 lds
    v_cvt_pk_bf16_f32 v100, v88, v88
    v_and_b32 v101, s4, v100
    v_sub_f32 v101, v88, v101
    v_cvt_pk_bf16_f32 v101, v101, v102
    v_mfma_f32_32x32x16_bf16 v[48:63], a[208:211], v[136:139], v[48:63]
    ds_read_b128 v[132:135], v2 offset:31744
    v_mul_f32 v38, v38, v46
    v_exp_f32 v87, v87
    v_mul_f32 v39, v39, v47
    v_fma_f32 v84, v84, v11, v11
    v_mfma_f32_32x32x16_bf16 v[48:63], a[212:215], v[140:143], v[48:63]
    ds_read_b128 v[136:139], v2 offset:32768
    buffer_load_dwordx4 v2, s[16:19], s61 offen offset:3072 sc1 lds
    s_addk_i32 s61, 4096
    v_fma_f32 v85, v85, v11, v11
    v_fma_f32 v86, v86, v11, v11
    s_waitcnt lgkmcnt(4)
    v_mfma_f32_32x32x16_bf16 v[48:63], a[216:219], v[144:147], v[48:63]
    ds_read_b128 v[140:143], v2 offset:33792
    v_fma_f32 v87, v87, v11, v11
    v_rcp_f32 v84, v84
    v_rcp_f32 v85, v85
    s_add_u32 m0, s68, 61440
    v_mfma_f32_32x32x16_bf16 v[48:63], a[220:223], v[148:151], v[48:63]
    ds_read_b128 v[144:147], v2 offset:34816
    buffer_load_dwordx4 v2, s[16:19], s61 offen offset:0 sc1 lds
    v_mul_f32 v36, v36, v84
    v_rcp_f32 v86, v86
    v_mfma_f32_32x32x16_bf16 v[48:63], v[100:103], v[104:107], v[48:63]
    v_mul_f32 v37, v37, v85
    v_rcp_f32 v87, v87
    v_mul_f32 v38, v38, v86
    v_cvt_pk_bf16_f32 v18, v36, v37
    v_mul_f32 v39, v39, v87
    v_cvt_pk_bf16_f32 v19, v38, v39
    v_mfma_f32_32x32x16_bf16 v[32:47], a[0:3], v[120:123], 0
    ds_read_b128 v[148:151], v2 offset:35840
    buffer_store_dwordx4 v[16:19], v2, s[16:19], s56 offen sc1
    s_add_u32 s56, s56, 14336
    s_waitcnt lgkmcnt(4)
    v_mfma_f32_32x32x16_bf16 v[32:47], a[4:7], v[124:127], v[32:47]
    ds_read_b128 v[120:123], v2 offset:36864
    s_waitcnt vmcnt(12)
    ds_read_b64_tr_b16 v[176:177], v156 offset:4096
    v_mfma_f32_32x32x16_bf16 v[32:47], a[8:11], v[128:131], v[32:47]
    ds_read_b128 v[124:127], v2 offset:37888
    ds_read_b64_tr_b16 v[178:179], v156 offset:4608
    buffer_load_dwordx4 v2, s[16:19], s61 offen offset:1024 sc1 lds
    v_mul_f32 v80, v48, v48
    v_mul_f32 v81, v49, v49
    v_mfma_f32_32x32x16_bf16 v[32:47], a[12:15], v[132:135], v[32:47]
    ds_read_b128 v[128:131], v2 offset:38912
    ds_read_b64_tr_b16 v[180:181], v157 offset:4096
    v_mul_f32 v82, v50, v50
    v_mul_f32 v83, v51, v51
    v_fma_f32 v80, v80, v10, v9
    v_fma_f32 v81, v81, v10, v9
    s_waitcnt lgkmcnt(7)
    v_mfma_f32_32x32x16_bf16 v[32:47], a[16:19], v[136:139], v[32:47]
    ds_read_b128 v[132:135], v2 offset:39936
    ds_read_b64_tr_b16 v[182:183], v157 offset:4608
    buffer_load_dwordx4 v2, s[16:19], s61 offen offset:2048 sc1 lds
    s_addk_i32 s61, 24576
    v_fma_f32 v82, v82, v10, v9
    v_mfma_f32_32x32x16_bf16 v[32:47], a[20:23], v[140:143], v[32:47]
    ds_read_b128 v[136:139], v2 offset:40960
    s_waitcnt vmcnt(12)
    ds_read_b64_tr_b16 v[184:185], v156 offset:6144
    v_fma_f32 v83, v83, v10, v9
    v_mul_f32 v80, v80, v48
    s_add_u32 m0, s47, 0
    v_mfma_f32_32x32x16_bf16 v[32:47], a[24:27], v[144:147], v[32:47]
    ds_read_b128 v[140:143], v2 offset:41984
    ds_read_b64_tr_b16 v[186:187], v156 offset:6656
    buffer_load_dwordx4 v152, s[32:35], s46 offen offset:0 lds
    v_mul_f32 v81, v81, v49
    s_waitcnt lgkmcnt(9)
    v_mfma_f32_32x32x16_bf16 v[32:47], a[28:31], v[148:151], v[32:47]
    ds_read_b128 v[144:147], v2 offset:43008
    ds_read_b64_tr_b16 v[188:189], v157 offset:6144
    v_mul_f32 v82, v82, v50
    v_mul_f32 v83, v83, v51
    v_exp_f32 v80, v80
    v_mfma_f32_32x32x16_bf16 v[32:47], a[32:35], v[120:123], v[32:47]
    ds_read_b128 v[148:151], v2 offset:44032
    ds_read_b64_tr_b16 v[190:191], v157 offset:6656
    buffer_load_dwordx4 v153, s[32:35], s46 offen offset:1024 lds
    v_mul_f32 v48, v48, v56
    v_exp_f32 v81, v81
    v_mfma_f32_32x32x16_bf16 v[32:47], a[36:39], v[124:127], v[32:47]
    ds_read_b128 v[120:123], v2 offset:45056
    v_mul_f32 v49, v49, v57
    v_exp_f32 v82, v82
    v_mul_f32 v50, v50, v58
    s_waitcnt lgkmcnt(8)
    v_mfma_f32_32x32x16_bf16 v[32:47], a[40:43], v[128:131], v[32:47]
    ds_read_b128 v[124:127], v2 offset:46080
    s_waitcnt vmcnt(12)
    ds_read_b64_tr_b16 v[192:193], v94 offset:28672
    buffer_load_dwordx4 v154, s[32:35], s46 offen offset:2048 lds
    v_exp_f32 v83, v83
    v_mfma_f32_32x32x16_bf16 v[32:47], a[44:47], v[132:135], v[32:47]
    ds_read_b128 v[128:131], v2 offset:47104
    ds_read_b64_tr_b16 v[194:195], v94 offset:29184
    v_mul_f32 v51, v51, v59
    v_fma_f32 v80, v80, v11, v11
    v_fma_f32 v81, v81, v11, v11
    v_fma_f32 v82, v82, v11, v11
    v_mfma_f32_32x32x16_bf16 v[32:47], a[48:51], v[136:139], v[32:47]
    ds_read_b128 v[132:135], v2 offset:48128
    ds_read_b64_tr_b16 v[196:197], v95 offset:28672
    buffer_load_dwordx4 v155, s[32:35], s46 offen offset:3072 lds
    s_add_u32 s46, s46, 229376
    s_waitcnt lgkmcnt(8)
    v_mfma_f32_32x32x16_bf16 v[32:47], a[52:55], v[140:143], v[32:47]
    ds_read_b128 v[136:139], v2 offset:49152
    ds_read_b64_tr_b16 v[198:199], v95 offset:29184
    v_fma_f32 v83, v83, v11, v11
    v_rcp_f32 v80, v80
    s_waitcnt lgkmcnt(9)
    s_add_u32 m0, s47, 4096
    v_mfma_f32_32x32x16_bf16 v[32:47], a[56:59], v[144:147], v[32:47]
    ds_read_b128 v[140:143], v2 offset:50176
    s_waitcnt vmcnt(12)
    ds_read_b64_tr_b16 v[200:201], v94 offset:30720
    buffer_load_dwordx4 v152, s[32:35], s46 offen offset:0 lds
    v_rcp_f32 v81, v81
    v_mfma_f32_32x32x16_bf16 v[32:47], a[60:63], v[148:151], v[32:47]
    ds_read_b128 v[144:147], v2 offset:51200
    ds_read_b64_tr_b16 v[202:203], v94 offset:31232
    v_mul_f32 v48, v48, v80
    v_rcp_f32 v82, v82
    s_waitcnt lgkmcnt(9)
    v_mfma_f32_32x32x16_bf16 v[32:47], a[64:67], v[120:123], v[32:47]
    ds_read_b128 v[148:151], v2 offset:52224
    ds_read_b64_tr_b16 v[204:205], v95 offset:30720
    buffer_load_dwordx4 v153, s[32:35], s46 offen offset:1024 lds
    v_mul_f32 v49, v49, v81
    v_mfma_f32_32x32x16_bf16 v[32:47], a[68:71], v[124:127], v[32:47]
    ds_read_b128 v[120:123], v2 offset:53248
    ds_read_b64_tr_b16 v[206:207], v95 offset:31232
    v_rcp_f32 v83, v83
    v_mul_f32 v50, v50, v82
    v_cvt_pk_bf16_f32 v20, v48, v49
    v_mul_f32 v51, v51, v83
    v_mfma_f32_32x32x16_bf16 v[32:47], a[72:75], v[128:131], v[32:47]
    ds_read_b128 v[124:127], v2 offset:54272
    buffer_load_dwordx4 v154, s[32:35], s46 offen offset:2048 lds
    v_cvt_pk_bf16_f32 v21, v50, v51
    v_mul_f32 v84, v52, v52
    v_mul_f32 v85, v53, v53
    s_waitcnt lgkmcnt(8)
    v_mfma_f32_32x32x16_bf16 v[32:47], a[76:79], v[132:135], v[32:47]
    ds_read_b128 v[128:131], v2 offset:55296
    v_mul_f32 v86, v54, v54
    v_mul_f32 v87, v55, v55
    v_fma_f32 v84, v84, v10, v9
    v_fma_f32 v85, v85, v10, v9
    v_fma_f32 v86, v86, v10, v9
    v_fma_f32 v87, v87, v10, v9
    v_mfma_f32_32x32x16_bf16 v[32:47], a[80:83], v[136:139], v[32:47]
    ds_read_b128 v[132:135], v2 offset:56320
    buffer_load_dwordx4 v155, s[32:35], s46 offen offset:3072 lds
    s_add_u32 s46, s46, 229376
    v_mul_f32 v84, v84, v52
    v_mul_f32 v85, v85, v53
    v_mfma_f32_32x32x16_bf16 v[32:47], a[84:87], v[140:143], v[32:47]
    ds_read_b128 v[136:139], v2 offset:28672
    v_mul_f32 v86, v86, v54
    v_mul_f32 v87, v87, v55
    v_exp_f32 v84, v84
    s_waitcnt lgkmcnt(4)
    s_add_u32 m0, s68, 86016
    v_mfma_f32_32x32x16_bf16 v[32:47], a[88:91], v[144:147], v[32:47]
    ds_read_b128 v[140:143], v2 offset:29696
    buffer_load_dwordx4 v2, s[16:19], s61 offen offset:0 sc1 lds
    ds_read_b128 v[12:15], v25 offset:512
    ds_read_b64 v[108:109], v25 offset:2560
    v_mul_f32 v52, v52, v60
    v_mfma_f32_32x32x16_bf16 v[32:47], a[92:95], v[148:151], v[32:47]
    ds_read_b128 v[144:147], v2 offset:30720
    v_exp_f32 v85, v85
    v_mul_f32 v53, v53, v61
    v_exp_f32 v86, v86
    v_mul_f32 v54, v54, v62
    v_mfma_f32_32x32x16_bf16 v[32:47], a[96:99], v[120:123], v[32:47]
    ds_read_b128 v[148:151], v2 offset:31744
    buffer_load_dwordx4 v2, s[16:19], s61 offen offset:1024 sc1 lds
    v_exp_f32 v87, v87
    v_mul_f32 v55, v55, v63
    s_waitcnt lgkmcnt(6)
    v_mfma_f32_32x32x16_bf16 v[32:47], a[100:103], v[124:127], v[32:47]
    ds_read_b128 v[120:123], v2 offset:32768
    v_fma_f32 v84, v84, v11, v11
    v_fma_f32 v85, v85, v11, v11
    v_fma_f32 v86, v86, v11, v11
    v_fma_f32 v87, v87, v11, v11
    v_rcp_f32 v84, v84
    v_mfma_f32_32x32x16_bf16 v[32:47], a[104:107], v[128:131], v[32:47]
    ds_read_b128 v[124:127], v2 offset:33792
    buffer_load_dwordx4 v2, s[16:19], s61 offen offset:2048 sc1 lds
    v_rcp_f32 v85, v85
    v_mul_f32 v52, v52, v84
    v_mfma_f32_32x32x16_bf16 v[32:47], a[108:111], v[132:135], v[32:47]
    ds_read_b128 v[128:131], v2 offset:34816
    v_rcp_f32 v86, v86
    v_mul_f32 v53, v53, v85
    v_rcp_f32 v87, v87
    s_waitcnt lgkmcnt(4)
    v_mfma_f32_32x32x16_bf16 v[32:47], v[96:99], v[108:111], v[32:47]
    buffer_load_dwordx4 v2, s[16:19], s61 offen offset:3072 sc1 lds
    s_addk_i32 s61, 4096
    v_mul_f32 v54, v54, v86
    v_cvt_pk_bf16_f32 v22, v52, v53
    v_mul_f32 v55, v55, v87
    v_cvt_pk_bf16_f32 v23, v54, v55
    v_mfma_f32_32x32x16_bf16 v[48:63], a[112:115], v[136:139], 0
    ds_read_b128 v[132:135], v2 offset:35840
    buffer_store_dwordx4 v[20:23], v2, s[16:19], s56 offen sc1
    s_add_u32 s56, s56, 100352
    v_mfma_f32_32x32x16_bf16 v[48:63], a[116:119], v[140:143], v[48:63]
    ds_read_b128 v[136:139], v2 offset:36864
    v_mfma_f32_32x32x16_bf16 v[48:63], a[120:123], v[144:147], v[48:63]
    ds_read_b128 v[140:143], v2 offset:37888
    v_mul_f32 v80, v32, v32
    v_mul_f32 v81, v33, v33
    v_mul_f32 v82, v34, v34
    v_mul_f32 v83, v35, v35
    s_waitcnt lgkmcnt(4)
    s_add_u32 m0, s68, 90112
    v_mfma_f32_32x32x16_bf16 v[48:63], a[124:127], v[148:151], v[48:63]
    ds_read_b128 v[144:147], v2 offset:38912
    buffer_load_dwordx4 v2, s[16:19], s61 offen offset:0 sc1 lds
    v_fma_f32 v80, v80, v14, v13
    v_fma_f32 v81, v81, v14, v13
    v_fma_f32 v82, v82, v14, v13
    v_mfma_f32_32x32x16_bf16 v[48:63], a[128:131], v[120:123], v[48:63]
    ds_read_b128 v[148:151], v2 offset:39936
    v_fma_f32 v83, v83, v14, v13
    v_mul_f32 v80, v80, v32
    v_mul_f32 v81, v81, v33
    v_mul_f32 v82, v82, v34
    v_mul_f32 v83, v83, v35
    v_mfma_f32_32x32x16_bf16 v[48:63], a[132:135], v[124:127], v[48:63]
    ds_read_b128 v[120:123], v2 offset:40960
    s_waitcnt vmcnt(12)
    ds_read_b64_tr_b16 v[208:209], v156 offset:0
    buffer_load_dwordx4 v2, s[16:19], s61 offen offset:1024 sc1 lds
    s_waitcnt lgkmcnt(5)
    v_mfma_f32_32x32x16_bf16 v[48:63], a[136:139], v[128:131], v[48:63]
    ds_read_b128 v[124:127], v2 offset:41984
    ds_read_b64_tr_b16 v[210:211], v156 offset:512
    v_exp_f32 v80, v80
    v_mul_f32 v32, v32, v40
    v_exp_f32 v81, v81
    v_mfma_f32_32x32x16_bf16 v[48:63], a[140:143], v[132:135], v[48:63]
    ds_read_b128 v[128:131], v2 offset:43008
    ds_read_b64_tr_b16 v[212:213], v157 offset:0
    buffer_load_dwordx4 v2, s[16:19], s61 offen offset:2048 sc1 lds
    s_addk_i32 s61, 24576
    v_mul_f32 v33, v33, v41
    v_mfma_f32_32x32x16_bf16 v[48:63], a[144:147], v[136:139], v[48:63]
    ds_read_b128 v[132:135], v2 offset:44032
    ds_read_b64_tr_b16 v[214:215], v157 offset:512
    v_exp_f32 v82, v82
    v_mul_f32 v34, v34, v42
    s_waitcnt lgkmcnt(8)
    v_mfma_f32_32x32x16_bf16 v[48:63], a[148:151], v[140:143], v[48:63]
    ds_read_b128 v[136:139], v2 offset:45056
    s_waitcnt vmcnt(12)
    ds_read_b64_tr_b16 v[216:217], v156 offset:2048
    v_exp_f32 v83, v83
    v_mul_f32 v35, v35, v43
    v_mfma_f32_32x32x16_bf16 v[48:63], a[152:155], v[144:147], v[48:63]
    ds_read_b128 v[140:143], v2 offset:46080
    ds_read_b64_tr_b16 v[218:219], v156 offset:2560
    v_fma_f32 v80, v80, v15, v15
    v_fma_f32 v81, v81, v15, v15
    v_fma_f32 v82, v82, v15, v15
    v_fma_f32 v83, v83, v15, v15
    v_mfma_f32_32x32x16_bf16 v[48:63], a[156:159], v[148:151], v[48:63]
    ds_read_b128 v[144:147], v2 offset:47104
    ds_read_b64_tr_b16 v[220:221], v157 offset:2048
    v_rcp_f32 v80, v80
    s_waitcnt lgkmcnt(9)
    v_mfma_f32_32x32x16_bf16 v[48:63], a[160:163], v[120:123], v[48:63]
    ds_read_b128 v[148:151], v2 offset:48128
    ds_read_b64_tr_b16 v[222:223], v157 offset:2560
    v_rcp_f32 v81, v81
    v_mul_f32 v32, v32, v80
    v_rcp_f32 v82, v82
    v_mfma_f32_32x32x16_bf16 v[48:63], a[164:167], v[124:127], v[48:63]
    ds_read_b128 v[120:123], v2 offset:49152
    s_waitcnt vmcnt(10)
    ds_read_b64_tr_b16 v[224:225], v156 offset:4096
    v_mul_f32 v33, v33, v81
    v_rcp_f32 v83, v83
    v_mfma_f32_32x32x16_bf16 v[48:63], a[168:171], v[128:131], v[48:63]
    ds_read_b128 v[124:127], v2 offset:50176
    ds_read_b64_tr_b16 v[226:227], v156 offset:4608
    v_mul_f32 v34, v34, v82
    v_cvt_pk_bf16_f32 v16, v32, v33
    v_mul_f32 v35, v35, v83
    s_waitcnt lgkmcnt(9)
    v_mfma_f32_32x32x16_bf16 v[48:63], a[172:175], v[132:135], v[48:63]
    ds_read_b128 v[128:131], v2 offset:51200
    ds_read_b64_tr_b16 v[228:229], v157 offset:4096
    v_cvt_pk_bf16_f32 v17, v34, v35
    v_mul_f32 v84, v36, v36
    s_waitcnt lgkmcnt(6)
    s_add_u32 m0, s47, 0
    v_mfma_f32_32x32x16_bf16 v[48:63], a[176:179], v[136:139], v[48:63]
    ds_read_b128 v[132:135], v2 offset:52224
    ds_read_b64_tr_b16 v[230:231], v157 offset:4608
    buffer_load_dwordx4 v152, s[32:35], s46 offen offset:0 lds
    v_mul_f32 v85, v37, v37
    v_mul_f32 v86, v38, v38
    v_mfma_f32_32x32x16_bf16 v[48:63], a[180:183], v[140:143], v[48:63]
    ds_read_b128 v[136:139], v2 offset:53248
    s_waitcnt vmcnt(9)
    ds_read_b64_tr_b16 v[232:233], v156 offset:6144
    v_mul_f32 v87, v39, v39
    v_fma_f32 v84, v84, v14, v13
    s_waitcnt lgkmcnt(9)
    v_mfma_f32_32x32x16_bf16 v[48:63], a[184:187], v[144:147], v[48:63]
    ds_read_b128 v[140:143], v2 offset:54272
    ds_read_b64_tr_b16 v[234:235], v156 offset:6656
    buffer_load_dwordx4 v153, s[32:35], s46 offen offset:1024 lds
    v_fma_f32 v85, v85, v14, v13
    v_fma_f32 v86, v86, v14, v13
    v_mfma_f32_32x32x16_bf16 v[48:63], a[188:191], v[148:151], v[48:63]
    ds_read_b128 v[144:147], v2 offset:55296
    ds_read_b64_tr_b16 v[236:237], v157 offset:6144
    v_fma_f32 v87, v87, v14, v13
    v_mul_f32 v84, v84, v36
    v_mul_f32 v85, v85, v37
    v_mul_f32 v86, v86, v38
    v_mfma_f32_32x32x16_bf16 v[48:63], a[192:195], v[120:123], v[48:63]
    ds_read_b128 v[148:151], v2 offset:56320
    ds_read_b64_tr_b16 v[238:239], v157 offset:6656
    buffer_load_dwordx4 v154, s[32:35], s46 offen offset:2048 lds
    v_mul_f32 v87, v87, v39
    s_waitcnt lgkmcnt(9)
    v_mfma_f32_32x32x16_bf16 v[48:63], a[196:199], v[124:127], v[48:63]
    s_barrier
    ds_read_b128 v[120:123], v24 offset:0
    v_exp_f32 v84, v84
    v_mul_f32 v36, v36, v44
    v_mfma_f32_32x32x16_bf16 v[48:63], a[200:203], v[128:131], v[48:63]
    ds_read_b128 v[124:127], v24 offset:1024
    buffer_load_dwordx4 v155, s[32:35], s46 offen offset:3072 lds
    s_add_u32 s46, s46, 229376
    v_exp_f32 v85, v85
    v_mul_f32 v37, v37, v45
    v_mfma_f32_32x32x16_bf16 v[48:63], a[204:207], v[132:135], v[48:63]
    ds_read_b128 v[128:131], v24 offset:2048
    v_exp_f32 v86, v86
    v_mul_f32 v38, v38, v46
    s_waitcnt lgkmcnt(3)
    s_add_u32 m0, s47, 4096
    v_mfma_f32_32x32x16_bf16 v[48:63], a[208:211], v[136:139], v[48:63]
    ds_read_b128 v[132:135], v24 offset:3072
    buffer_load_dwordx4 v152, s[32:35], s46 offen offset:0 lds
    v_exp_f32 v87, v87
    v_mul_f32 v39, v39, v47
    v_mfma_f32_32x32x16_bf16 v[48:63], a[212:215], v[140:143], v[48:63]
    ds_read_b128 v[136:139], v24 offset:4096
    v_fma_f32 v84, v84, v15, v15
    v_fma_f32 v85, v85, v15, v15
    v_fma_f32 v86, v86, v15, v15
    v_fma_f32 v87, v87, v15, v15
    v_rcp_f32 v84, v84
    v_mfma_f32_32x32x16_bf16 v[48:63], a[216:219], v[144:147], v[48:63]
    ds_read_b128 v[140:143], v24 offset:5120
    buffer_load_dwordx4 v153, s[32:35], s46 offen offset:1024 lds
    v_rcp_f32 v85, v85
    s_waitcnt lgkmcnt(4)
    v_mfma_f32_32x32x16_bf16 v[48:63], a[220:223], v[148:151], v[48:63]
    ds_read_b128 v[144:147], v24 offset:6144
    v_mul_f32 v36, v36, v84
    v_rcp_f32 v86, v86
    v_mul_f32 v37, v37, v85
    v_rcp_f32 v87, v87
    v_mfma_f32_32x32x16_bf16 v[48:63], v[100:103], v[108:111], v[48:63]
    buffer_load_dwordx4 v154, s[32:35], s46 offen offset:2048 lds
    v_mul_f32 v38, v38, v86
    v_cvt_pk_bf16_f32 v18, v36, v37
    v_mul_f32 v39, v39, v87
    v_cvt_pk_bf16_f32 v19, v38, v39
    v_mfma_f32_32x32x16_bf16 v[32:47], a[0:3], v[120:123], 0
    ds_read_b128 v[148:151], v24 offset:7168
    buffer_store_dwordx4 v[16:19], v2, s[16:19], s56 offen sc1
    s_add_u32 s56, s56, 14336
    v_mfma_f32_32x32x16_bf16 v[32:47], a[4:7], v[124:127], v[32:47]
    ds_read_b128 v[120:123], v24 offset:8192
    s_waitcnt lgkmcnt(4)
    v_mfma_f32_32x32x16_bf16 v[32:47], a[8:11], v[128:131], v[32:47]
    ds_read_b128 v[124:127], v24 offset:9216
    s_barrier
    v_mul_f32 v80, v48, v48
    v_mul_f32 v81, v49, v49
    v_mul_f32 v82, v50, v50
    v_mul_f32 v83, v51, v51
    v_mfma_f32_32x32x16_bf16 v[32:47], a[12:15], v[132:135], v[32:47]
    ds_read_b128 v[128:131], v24 offset:10240
    buffer_load_dwordx4 v155, s[32:35], s46 offen offset:3072 lds
    s_sub_u32 s46, s46, 1318912
    v_fma_f32 v80, v80, v14, v13
    v_fma_f32 v81, v81, v14, v13
    v_mfma_f32_32x32x16_bf16 v[32:47], a[16:19], v[136:139], v[32:47]
    ds_read_b128 v[132:135], v24 offset:11264
    v_fma_f32 v82, v82, v14, v13
    v_fma_f32 v83, v83, v14, v13
    v_mul_f32 v80, v80, v48
    v_mul_f32 v81, v81, v49
    v_mul_f32 v82, v82, v50
    s_waitcnt lgkmcnt(4)
    v_mfma_f32_32x32x16_bf16 v[32:47], a[20:23], v[140:143], v[32:47]
    ds_read_b128 v[136:139], v24 offset:12288
    buffer_store_dwordx4 v[112:115], v2, s[16:19], s73 offen sc1
    s_addk_i32 s73, 14336
    v_mul_f32 v83, v83, v51
    v_mfma_f32_32x32x16_bf16 v[32:47], a[24:27], v[144:147], v[32:47]
    ds_read_b128 v[140:143], v24 offset:13312
    v_exp_f32 v80, v80
    v_mul_f32 v48, v48, v56
    v_exp_f32 v81, v81
    v_mul_f32 v49, v49, v57
    v_mfma_f32_32x32x16_bf16 v[32:47], a[28:31], v[148:151], v[32:47]
    ds_read_b128 v[144:147], v24 offset:14336
    buffer_store_dwordx4 v[112:115], v2, s[16:19], s73 offen sc1
    s_addk_i32 s73, 14336
    v_exp_f32 v82, v82
    s_waitcnt lgkmcnt(4)
    v_mfma_f32_32x32x16_bf16 v[32:47], a[32:35], v[120:123], v[32:47]
    ds_read_b128 v[148:151], v24 offset:15360
    v_mul_f32 v50, v50, v58
    v_exp_f32 v83, v83
    s_add_u32 m0, s6, 0
    v_mfma_f32_32x32x16_bf16 v[32:47], a[36:39], v[124:127], v[32:47]
    ds_read_b128 v[120:123], v24 offset:16384
    buffer_load_dwordx4 v152, s[32:35], s60 offen offset:0 lds
    v_mul_f32 v51, v51, v59
    v_fma_f32 v80, v80, v15, v15
    v_fma_f32 v81, v81, v15, v15
    v_mfma_f32_32x32x16_bf16 v[32:47], a[40:43], v[128:131], v[32:47]
    ds_read_b128 v[124:127], v24 offset:17408
    v_fma_f32 v82, v82, v15, v15
    v_fma_f32 v83, v83, v15, v15
    v_rcp_f32 v80, v80
    s_waitcnt lgkmcnt(4)
    v_mfma_f32_32x32x16_bf16 v[32:47], a[44:47], v[132:135], v[32:47]
    ds_read_b128 v[128:131], v24 offset:18432
    buffer_load_dwordx4 v153, s[32:35], s60 offen offset:1024 lds
    v_rcp_f32 v81, v81
    v_mul_f32 v48, v48, v80
    v_mfma_f32_32x32x16_bf16 v[32:47], a[48:51], v[136:139], v[32:47]
    ds_read_b128 v[132:135], v24 offset:19456
    v_rcp_f32 v82, v82
    v_mul_f32 v49, v49, v81
    v_rcp_f32 v83, v83
    v_mul_f32 v50, v50, v82
    v_mfma_f32_32x32x16_bf16 v[32:47], a[52:55], v[140:143], v[32:47]
    ds_read_b128 v[136:139], v24 offset:20480
    buffer_load_dwordx4 v154, s[32:35], s60 offen offset:2048 lds
    v_cvt_pk_bf16_f32 v20, v48, v49
    v_mul_f32 v51, v51, v83
    s_waitcnt lgkmcnt(4)
    v_mfma_f32_32x32x16_bf16 v[32:47], a[56:59], v[144:147], v[32:47]
    ds_read_b128 v[140:143], v24 offset:21504
    v_cvt_pk_bf16_f32 v21, v50, v51
    v_mul_f32 v84, v52, v52
    v_mul_f32 v85, v53, v53
    v_mul_f32 v86, v54, v54
    v_mul_f32 v87, v55, v55
    v_mfma_f32_32x32x16_bf16 v[32:47], a[60:63], v[148:151], v[32:47]
    ds_read_b128 v[144:147], v24 offset:22528
    s_waitcnt vmcnt(12)
    ds_read_b64_tr_b16 v[240:241], v156 offset:0
    buffer_load_dwordx4 v155, s[32:35], s60 offen offset:3072 lds
    s_add_u32 s60, s60, 229376
    v_mfma_f32_32x32x16_bf16 v[32:47], a[64:67], v[120:123], v[32:47]
    ds_read_b128 v[148:151], v24 offset:23552
    ds_read_b64_tr_b16 v[242:243], v156 offset:512
    v_fma_f32 v84, v84, v14, v13
    v_fma_f32 v85, v85, v14, v13
    v_fma_f32 v86, v86, v14, v13
    s_waitcnt lgkmcnt(6)
    v_mfma_f32_32x32x16_bf16 v[32:47], a[68:71], v[124:127], v[32:47]
    ds_read_b128 v[120:123], v24 offset:24576
    ds_read_b64_tr_b16 v[244:245], v157 offset:0
    v_fma_f32 v87, v87, v14, v13
    v_mul_f32 v84, v84, v52
    v_mul_f32 v85, v85, v53
    v_mfma_f32_32x32x16_bf16 v[32:47], a[72:75], v[128:131], v[32:47]
    ds_read_b128 v[124:127], v24 offset:25600
    ds_read_b64_tr_b16 v[246:247], v157 offset:512
    v_mul_f32 v86, v86, v54
    v_mul_f32 v87, v87, v55
    v_exp_f32 v84, v84
    v_mfma_f32_32x32x16_bf16 v[32:47], a[76:79], v[132:135], v[32:47]
    ds_read_b128 v[128:131], v24 offset:26624
    s_waitcnt vmcnt(11)
    ds_read_b64_tr_b16 v[248:249], v156 offset:2048
    v_mul_f32 v52, v52, v60
    s_waitcnt lgkmcnt(9)
    v_mfma_f32_32x32x16_bf16 v[32:47], a[80:83], v[136:139], v[32:47]
    ds_read_b128 v[132:135], v24 offset:27648
    ds_read_b64_tr_b16 v[250:251], v156 offset:2560
    v_exp_f32 v85, v85
    v_mul_f32 v53, v53, v61
    v_exp_f32 v86, v86
    v_mfma_f32_32x32x16_bf16 v[32:47], a[84:87], v[140:143], v[32:47]
    ds_read_b128 v[136:139], v24 offset:0
    ds_read_b64_tr_b16 v[252:253], v157 offset:2048
    v_mul_f32 v54, v54, v62
    v_exp_f32 v87, v87
    v_mfma_f32_32x32x16_bf16 v[32:47], a[88:91], v[144:147], v[32:47]
    ds_read_b128 v[140:143], v24 offset:1024
    ds_read_b64_tr_b16 v[254:255], v157 offset:2560
    ds_read_b128 v[8:11], v25 offset:1024
    ds_read_b64 v[104:105], v25 offset:3072
    s_waitcnt lgkmcnt(11)
    v_mfma_f32_32x32x16_bf16 v[32:47], a[92:95], v[148:151], v[32:47]
    ds_read_b128 v[144:147], v24 offset:2048
    v_mul_f32 v55, v55, v63
    v_fma_f32 v84, v84, v15, v15
    v_fma_f32 v85, v85, v15, v15
    v_fma_f32 v86, v86, v15, v15
    v_fma_f32 v87, v87, v15, v15
    v_mfma_f32_32x32x16_bf16 v[32:47], a[96:99], v[120:123], v[32:47]
    ds_read_b128 v[148:151], v24 offset:3072
    v_rcp_f32 v84, v84
    v_rcp_f32 v85, v85
    v_mul_f32 v52, v52, v84
    v_mfma_f32_32x32x16_bf16 v[32:47], a[100:103], v[124:127], v[32:47]
    ds_read_b128 v[120:123], v24 offset:4096
    s_waitcnt vmcnt(7)
    s_addk_i32 s7, 128
    s_mov_b64 exec, 1
    buffer_store_dword v28, off, s[16:19], s7 sc1
    s_mov_b64 exec, -1
    s_waitcnt lgkmcnt(8)
    v_mfma_f32_32x32x16_bf16 v[32:47], a[104:107], v[128:131], v[32:47]
    ds_read_b128 v[124:127], v24 offset:5120
    v_rcp_f32 v86, v86
    v_mul_f32 v53, v53, v85
    s_waitcnt lgkmcnt(6)
    s_add_u32 m0, s47, 0
    v_mfma_f32_32x32x16_bf16 v[32:47], a[108:111], v[132:135], v[32:47]
    ds_read_b128 v[128:131], v24 offset:6144
    ds_read_b64_tr_b16 a[224:225], v156 offset:4096
    buffer_load_dwordx4 v152, s[32:35], s46 offen offset:0 lds
    v_rcp_f32 v87, v87
    s_waitcnt lgkmcnt(6)
    v_mfma_f32_32x32x16_bf16 v[32:47], v[96:99], v[104:107], v[32:47]
    ds_read_b64_tr_b16 a[226:227], v156 offset:4608
    v_mul_f32 v54, v54, v86
    v_cvt_pk_bf16_f32 v22, v52, v53
    v_mul_f32 v55, v55, v87
    v_cvt_pk_bf16_f32 v23, v54, v55
    v_mfma_f32_32x32x16_bf16 v[48:63], a[112:115], v[136:139], 0
    ds_read_b128 v[132:135], v24 offset:7168
    buffer_store_dwordx4 v[20:23], v2, s[16:19], s56 offen sc1
    s_add_u32 s56, s56, 100352
    ds_read_b64_tr_b16 a[228:229], v157 offset:4096
    s_waitcnt lgkmcnt(7)
    v_mfma_f32_32x32x16_bf16 v[48:63], a[116:119], v[140:143], v[48:63]
    ds_read_b128 v[136:139], v24 offset:8192
    ds_read_b64_tr_b16 a[230:231], v157 offset:4608
    v_mfma_f32_32x32x16_bf16 v[48:63], a[120:123], v[144:147], v[48:63]
    ds_read_b128 v[140:143], v24 offset:9216
    s_waitcnt vmcnt(9)
    ds_read_b64_tr_b16 a[232:233], v156 offset:6144
    buffer_load_dwordx4 v153, s[32:35], s46 offen offset:1024 lds
    v_mul_f32 v80, v32, v32
    v_mfma_f32_32x32x16_bf16 v[48:63], a[124:127], v[148:151], v[48:63]
    ds_read_b128 v[144:147], v24 offset:10240
    ds_read_b64_tr_b16 a[234:235], v156 offset:6656
    v_mul_f32 v81, v33, v33
    v_mul_f32 v82, v34, v34
    v_mul_f32 v83, v35, v35
    s_waitcnt lgkmcnt(10)
    v_mfma_f32_32x32x16_bf16 v[48:63], a[128:131], v[120:123], v[48:63]
    ds_read_b128 v[148:151], v24 offset:11264
    ds_read_b64_tr_b16 a[236:237], v157 offset:6144
    buffer_load_dwordx4 v154, s[32:35], s46 offen offset:2048 lds
    v_fma_f32 v80, v80, v10, v9
    v_mfma_f32_32x32x16_bf16 v[48:63], a[132:135], v[124:127], v[48:63]
    ds_read_b128 v[120:123], v24 offset:12288
    ds_read_b64_tr_b16 a[238:239], v157 offset:6656
    v_fma_f32 v81, v81, v10, v9
    v_fma_f32 v82, v82, v10, v9
    v_fma_f32 v83, v83, v10, v9
    v_mul_f32 v80, v80, v32
    v_mfma_f32_32x32x16_bf16 v[48:63], a[136:139], v[128:131], v[48:63]
    ds_read_b128 v[124:127], v24 offset:13312
    buffer_load_dwordx4 v155, s[32:35], s46 offen offset:3072 lds
    s_add_u32 s46, s46, 229376
    v_mul_f32 v81, v81, v33
    s_waitcnt lgkmcnt(8)
    v_mfma_f32_32x32x16_bf16 v[48:63], a[140:143], v[132:135], v[48:63]
    ds_read_b128 v[128:131], v24 offset:14336
    v_mul_f32 v82, v82, v34
    v_mul_f32 v83, v83, v35
    v_exp_f32 v80, v80
    v_mul_f32 v32, v32, v40
    v_mfma_f32_32x32x16_bf16 v[48:63], a[144:147], v[136:139], v[48:63]
    ds_read_b128 v[132:135], v24 offset:15360
    v_exp_f32 v81, v81
    v_mul_f32 v33, v33, v41
    v_exp_f32 v82, v82
    s_waitcnt lgkmcnt(3)
    s_add_u32 m0, s47, 4096
    v_mfma_f32_32x32x16_bf16 v[48:63], a[148:151], v[140:143], v[48:63]
    ds_read_b128 v[136:139], v24 offset:16384
    buffer_load_dwordx4 v152, s[32:35], s46 offen offset:0 lds
    v_mul_f32 v34, v34, v42
    v_mfma_f32_32x32x16_bf16 v[48:63], a[152:155], v[144:147], v[48:63]
    ds_read_b128 v[140:143], v24 offset:17408
    v_exp_f32 v83, v83
    v_mul_f32 v35, v35, v43
    v_fma_f32 v80, v80, v11, v11
    v_fma_f32 v81, v81, v11, v11
    v_fma_f32 v82, v82, v11, v11
    v_mfma_f32_32x32x16_bf16 v[48:63], a[156:159], v[148:151], v[48:63]
    ds_read_b128 v[144:147], v24 offset:18432
    buffer_load_dwordx4 v153, s[32:35], s46 offen offset:1024 lds
    v_fma_f32 v83, v83, v11, v11
    v_rcp_f32 v80, v80
    v_mfma_f32_32x32x16_bf16 v[48:63], a[160:163], v[120:123], v[48:63]
    ds_read_b128 v[148:151], v24 offset:19456
    v_rcp_f32 v81, v81
    v_mul_f32 v32, v32, v80
    s_waitcnt lgkmcnt(4)
    v_mfma_f32_32x32x16_bf16 v[48:63], a[164:167], v[124:127], v[48:63]
    ds_read_b128 v[120:123], v24 offset:20480
    buffer_load_dwordx4 v154, s[32:35], s46 offen offset:2048 lds
    v_rcp_f32 v82, v82
    v_mul_f32 v33, v33, v81
    v_rcp_f32 v83, v83
    v_mfma_f32_32x32x16_bf16 v[48:63], a[168:171], v[128:131], v[48:63]
    ds_read_b128 v[124:127], v24 offset:21504
    v_mul_f32 v34, v34, v82
    v_cvt_pk_bf16_f32 v16, v32, v33
    v_mul_f32 v35, v35, v83
    v_cvt_pk_bf16_f32 v17, v34, v35
    v_mfma_f32_32x32x16_bf16 v[48:63], a[172:175], v[132:135], v[48:63]
    ds_read_b128 v[128:131], v24 offset:22528
    buffer_load_dwordx4 v155, s[32:35], s46 offen offset:3072 lds
    s_add_u32 s46, s46, 229376
    v_mul_f32 v84, v36, v36
    v_mul_f32 v85, v37, v37
    s_waitcnt lgkmcnt(4)
    v_mfma_f32_32x32x16_bf16 v[48:63], a[176:179], v[136:139], v[48:63]
    ds_read_b128 v[132:135], v24 offset:23552
    v_mul_f32 v86, v38, v38
    v_mul_f32 v87, v39, v39
    v_fma_f32 v84, v84, v10, v9
    v_fma_f32 v85, v85, v10, v9
    s_add_u32 m0, s6, 16384
    v_mfma_f32_32x32x16_bf16 v[48:63], a[180:183], v[140:143], v[48:63]
    ds_read_b128 v[136:139], v24 offset:24576
    buffer_load_dwordx4 v152, s[32:35], s60 offen offset:0 lds
    v_fma_f32 v86, v86, v10, v9
    v_fma_f32 v87, v87, v10, v9
    v_mul_f32 v84, v84, v36
    v_mfma_f32_32x32x16_bf16 v[48:63], a[184:187], v[144:147], v[48:63]
    ds_read_b128 v[140:143], v24 offset:25600
    v_mul_f32 v85, v85, v37
    v_mul_f32 v86, v86, v38
    v_mul_f32 v87, v87, v39
    v_exp_f32 v84, v84
    s_waitcnt lgkmcnt(4)
    v_mfma_f32_32x32x16_bf16 v[48:63], a[188:191], v[148:151], v[48:63]
    ds_read_b128 v[144:147], v24 offset:26624
    buffer_load_dwordx4 v153, s[32:35], s60 offen offset:1024 lds
    v_mul_f32 v36, v36, v44
    v_exp_f32 v85, v85
    v_mfma_f32_32x32x16_bf16 v[48:63], a[192:195], v[120:123], v[48:63]
    ds_read_b128 v[148:151], v24 offset:27648
    v_mul_f32 v37, v37, v45
    v_exp_f32 v86, v86
    v_mul_f32 v38, v38, v46
    v_mfma_f32_32x32x16_bf16 v[48:63], a[196:199], v[124:127], v[48:63]
    s_barrier
    ds_read_b128 v[120:123], v24 offset:28672
    buffer_load_dwordx4 v154, s[32:35], s60 offen offset:2048 lds
    v_exp_f32 v87, v87
    s_waitcnt lgkmcnt(4)
    v_mfma_f32_32x32x16_bf16 v[48:63], a[200:203], v[128:131], v[48:63]
    ds_read_b128 v[124:127], v24 offset:29696
    v_mul_f32 v39, v39, v47
    v_fma_f32 v84, v84, v11, v11
    v_fma_f32 v85, v85, v11, v11
    v_fma_f32 v86, v86, v11, v11
    v_fma_f32 v87, v87, v11, v11
    v_mfma_f32_32x32x16_bf16 v[48:63], a[204:207], v[132:135], v[48:63]
    ds_read_b128 v[128:131], v24 offset:30720
    buffer_load_dwordx4 v155, s[32:35], s60 offen offset:3072 lds
    s_add_u32 s60, s60, 229376
    v_rcp_f32 v84, v84
    v_mfma_f32_32x32x16_bf16 v[48:63], a[208:211], v[136:139], v[48:63]
    ds_read_b128 v[132:135], v24 offset:31744
    v_rcp_f32 v85, v85
    v_mul_f32 v36, v36, v84
    v_rcp_f32 v86, v86
    s_waitcnt lgkmcnt(4)
    v_mfma_f32_32x32x16_bf16 v[48:63], a[212:215], v[140:143], v[48:63]
    ds_read_b128 v[136:139], v24 offset:32768
    s_waitcnt vmcnt(11)
    s_addk_i32 s7, 128
    s_mov_b64 exec, 1
    buffer_store_dword v28, off, s[16:19], s7 sc1
    s_mov_b64 exec, -1
    s_add_u32 m0, s6, 32768
    v_mfma_f32_32x32x16_bf16 v[48:63], a[216:219], v[144:147], v[48:63]
    ds_read_b128 v[140:143], v24 offset:33792
    buffer_load_dwordx4 v152, s[32:35], s60 offen offset:0 lds
    v_mul_f32 v37, v37, v85
    v_rcp_f32 v87, v87
    v_mfma_f32_32x32x16_bf16 v[48:63], a[220:223], v[148:151], v[48:63]
    ds_read_b128 v[144:147], v24 offset:34816
    s_mov_b64 exec, 0x3fff
    buffer_load_dword v6, v5, s[16:19], s53 offen sc1
    s_mov_b64 exec, -1
    s_waitcnt lgkmcnt(4)
    v_mfma_f32_32x32x16_bf16 v[48:63], v[100:103], v[104:107], v[48:63]
    s_waitcnt vmcnt(13)
    ds_read_b64_tr_b16 a[240:241], v156 offset:0
    v_mul_f32 v38, v38, v86
    v_cvt_pk_bf16_f32 v18, v36, v37
    v_mul_f32 v39, v39, v87
    v_cvt_pk_bf16_f32 v19, v38, v39
    v_mfma_f32_32x32x16_bf16 v[32:47], a[0:3], v[120:123], 0
    ds_read_b128 v[148:151], v24 offset:35840
    buffer_store_dwordx4 v[16:19], v2, s[16:19], s56 offen sc1
    s_add_u32 s56, s56, 14336
    ds_read_b64_tr_b16 a[242:243], v156 offset:512
    v_mfma_f32_32x32x16_bf16 v[32:47], a[4:7], v[124:127], v[32:47]
    ds_read_b128 v[120:123], v24 offset:36864
    ds_read_b64_tr_b16 a[244:245], v157 offset:0
    v_mfma_f32_32x32x16_bf16 v[32:47], a[8:11], v[128:131], v[32:47]
    ds_read_b128 v[124:127], v24 offset:37888
    ds_read_b64_tr_b16 a[246:247], v157 offset:512
    buffer_load_dwordx4 v153, s[32:35], s60 offen offset:1024 lds
    s_barrier
    s_waitcnt lgkmcnt(8)
    v_mfma_f32_32x32x16_bf16 v[32:47], a[12:15], v[132:135], v[32:47]
    ds_read_b128 v[128:131], v24 offset:38912
    s_waitcnt vmcnt(13)
    ds_read_b64_tr_b16 a[248:249], v156 offset:2048
    v_mul_f32 v80, v48, v48
    v_mul_f32 v81, v49, v49
    v_mul_f32 v82, v50, v50
    v_mfma_f32_32x32x16_bf16 v[32:47], a[16:19], v[136:139], v[32:47]
    ds_read_b128 v[132:135], v24 offset:39936
    ds_read_b64_tr_b16 a[250:251], v156 offset:2560
    buffer_load_dwordx4 v154, s[32:35], s60 offen offset:2048 lds
    v_mul_f32 v83, v51, v51
    v_mfma_f32_32x32x16_bf16 v[32:47], a[20:23], v[140:143], v[32:47]
    ds_read_b128 v[136:139], v24 offset:40960
    ds_read_b64_tr_b16 a[252:253], v157 offset:2048
    v_fma_f32 v80, v80, v10, v9
    v_fma_f32 v81, v81, v10, v9
    v_fma_f32 v82, v82, v10, v9
    s_waitcnt lgkmcnt(9)
    v_mfma_f32_32x32x16_bf16 v[32:47], a[24:27], v[144:147], v[32:47]
    ds_read_b128 v[140:143], v24 offset:41984
    ds_read_b64_tr_b16 a[254:255], v157 offset:2560
    buffer_load_dwordx4 v155, s[32:35], s60 offen offset:3072 lds
    s_add_u32 s60, s60, 229376
    v_mfma_f32_32x32x16_bf16 v[32:47], a[28:31], v[148:151], v[32:47]
    ds_read_b128 v[144:147], v24 offset:43008
    v_fma_f32 v83, v83, v10, v9
    v_mul_f32 v80, v80, v48
    v_mul_f32 v81, v81, v49
    v_mul_f32 v82, v82, v50
    v_mul_f32 v83, v83, v51
    v_mfma_f32_32x32x16_bf16 v[32:47], a[32:35], v[120:123], v[32:47]
    ds_read_b128 v[148:151], v24 offset:44032
    v_exp_f32 v80, v80
    v_mul_f32 v48, v48, v56
    v_exp_f32 v81, v81
    s_waitcnt lgkmcnt(7)
    v_mfma_f32_32x32x16_bf16 v[32:47], a[36:39], v[124:127], v[32:47]
    ds_read_b128 v[120:123], v24 offset:45056
    v_mul_f32 v49, v49, v57
    v_exp_f32 v82, v82
    s_waitcnt lgkmcnt(3)
    s_add_u32 m0, s47, 0
    v_mfma_f32_32x32x16_bf16 v[32:47], a[40:43], v[128:131], v[32:47]
    ds_read_b128 v[124:127], v24 offset:46080
    buffer_load_dwordx4 v152, s[32:35], s46 offen offset:0 lds
    v_mul_f32 v50, v50, v58
    v_exp_f32 v83, v83
    v_mfma_f32_32x32x16_bf16 v[32:47], a[44:47], v[132:135], v[32:47]
    ds_read_b128 v[128:131], v24 offset:47104
    v_mul_f32 v51, v51, v59
    v_fma_f32 v80, v80, v11, v11
    v_fma_f32 v81, v81, v11, v11
    s_waitcnt lgkmcnt(4)
    v_mfma_f32_32x32x16_bf16 v[32:47], a[48:51], v[136:139], v[32:47]
    ds_read_b128 v[132:135], v24 offset:48128
    buffer_load_dwordx4 v153, s[32:35], s46 offen offset:1024 lds
    v_fma_f32 v82, v82, v11, v11
    v_fma_f32 v83, v83, v11, v11
    v_rcp_f32 v80, v80
    v_mfma_f32_32x32x16_bf16 v[32:47], a[52:55], v[140:143], v[32:47]
    ds_read_b128 v[136:139], v24 offset:49152
    v_rcp_f32 v81, v81
    v_mul_f32 v48, v48, v80
    v_rcp_f32 v82, v82
    v_mfma_f32_32x32x16_bf16 v[32:47], a[56:59], v[144:147], v[32:47]
    ds_read_b128 v[140:143], v24 offset:50176
    buffer_load_dwordx4 v154, s[32:35], s46 offen offset:2048 lds
    v_mul_f32 v49, v49, v81
    s_waitcnt lgkmcnt(4)
    v_mfma_f32_32x32x16_bf16 v[32:47], a[60:63], v[148:151], v[32:47]
    ds_read_b128 v[144:147], v24 offset:51200
    v_rcp_f32 v83, v83
    v_mul_f32 v50, v50, v82
    v_cvt_pk_bf16_f32 v20, v48, v49
    v_mul_f32 v51, v51, v83
    v_mfma_f32_32x32x16_bf16 v[32:47], a[64:67], v[120:123], v[32:47]
    ds_read_b128 v[148:151], v24 offset:52224
    buffer_load_dwordx4 v155, s[32:35], s46 offen offset:3072 lds
    v_cvt_pk_bf16_f32 v21, v50, v51
    v_mul_f32 v84, v52, v52
    v_mul_f32 v85, v53, v53
    v_mfma_f32_32x32x16_bf16 v[32:47], a[68:71], v[124:127], v[32:47]
    ds_read_b128 v[120:123], v24 offset:53248
    v_mul_f32 v86, v54, v54
    v_mul_f32 v87, v55, v55
    v_fma_f32 v84, v84, v10, v9
    s_waitcnt lgkmcnt(4)
    s_add_u32 m0, s6, 49152
    v_mfma_f32_32x32x16_bf16 v[32:47], a[72:75], v[128:131], v[32:47]
    ds_read_b128 v[124:127], v24 offset:54272
    buffer_load_dwordx4 v152, s[32:35], s60 offen offset:0 lds
    v_fma_f32 v85, v85, v10, v9
    v_fma_f32 v86, v86, v10, v9
    v_fma_f32 v87, v87, v10, v9
    v_mfma_f32_32x32x16_bf16 v[32:47], a[76:79], v[132:135], v[32:47]
    ds_read_b128 v[128:131], v24 offset:55296
    v_mul_f32 v84, v84, v52
    v_mul_f32 v85, v85, v53
    v_mul_f32 v86, v86, v54
    v_mul_f32 v87, v87, v55
    v_exp_f32 v84, v84
    v_mfma_f32_32x32x16_bf16 v[32:47], a[80:83], v[136:139], v[32:47]
    ds_read_b128 v[132:135], v24 offset:56320
    buffer_load_dwordx4 v153, s[32:35], s60 offen offset:1024 lds
    v_mul_f32 v52, v52, v60
    s_waitcnt lgkmcnt(4)
    v_mfma_f32_32x32x16_bf16 v[32:47], a[84:87], v[140:143], v[32:47]
    ds_read_b128 v[136:139], v24 offset:28672
    v_exp_f32 v85, v85
    v_mul_f32 v53, v53, v61
    v_exp_f32 v86, v86
    v_mfma_f32_32x32x16_bf16 v[32:47], a[88:91], v[144:147], v[32:47]
    ds_read_b128 v[140:143], v24 offset:29696
    buffer_load_dwordx4 v154, s[32:35], s60 offen offset:2048 lds
    ds_read_b128 v[12:15], v25 offset:1536
    ds_read_b64 v[108:109], v25 offset:3584
    v_mul_f32 v54, v54, v62
    v_mfma_f32_32x32x16_bf16 v[32:47], a[92:95], v[148:151], v[32:47]
    ds_read_b128 v[144:147], v24 offset:30720
    v_exp_f32 v87, v87
    v_mul_f32 v55, v55, v63
    v_fma_f32 v84, v84, v11, v11
    s_waitcnt vmcnt(11) lgkmcnt(6)
    v_cmp_eq_u32 vcc, -1, v6
    s_nop 0
    s_and_b32 s64, vcc_lo, 0x3fff
    s_cbranch_scc1 L_fhha_no
L_fhha_ok:
    s_addk_i32 s53, 128
    v_mfma_f32_32x32x16_bf16 v[32:47], a[96:99], v[120:123], v[32:47]
    ds_read_b128 v[148:151], v24 offset:31744
    buffer_load_dwordx4 v155, s[32:35], s60 offen offset:3072 lds
    v_fma_f32 v85, v85, v11, v11
    v_fma_f32 v86, v86, v11, v11
    v_fma_f32 v87, v87, v11, v11
    v_mfma_f32_32x32x16_bf16 v[32:47], a[100:103], v[124:127], v[32:47]
    ds_read_b128 v[120:123], v24 offset:32768
    v_rcp_f32 v84, v84
    v_rcp_f32 v85, v85
    v_mul_f32 v52, v52, v84
    v_mfma_f32_32x32x16_bf16 v[32:47], a[104:107], v[128:131], v[32:47]
    ds_read_b128 v[124:127], v24 offset:33792
    buffer_load_dwordx4 a[0:3], v2, s[16:19], s54 offen offset:0 sc1
    v_rcp_f32 v86, v86
    s_waitcnt lgkmcnt(6)
    v_mfma_f32_32x32x16_bf16 v[32:47], a[108:111], v[132:135], v[32:47]
    ds_read_b128 v[128:131], v24 offset:34816
    s_mov_b64 exec, 0x3fff
    buffer_load_dword v6, v5, s[16:19], s53 offen sc1
    s_mov_b64 exec, -1
    v_mul_f32 v53, v53, v85
    s_waitcnt lgkmcnt(5)
    v_mfma_f32_32x32x16_bf16 v[32:47], v[96:99], v[108:111], v[32:47]
    v_rcp_f32 v87, v87
    v_mul_f32 v54, v54, v86
    v_cvt_pk_bf16_f32 v22, v52, v53
    v_mul_f32 v55, v55, v87
    v_cvt_pk_bf16_f32 v23, v54, v55
    v_mfma_f32_32x32x16_bf16 v[48:63], a[112:115], v[136:139], 0
    ds_read_b128 v[132:135], v24 offset:35840
    buffer_store_dwordx4 v[20:23], v2, s[16:19], s56 offen sc1
    s_add_u32 s56, s56, 100352
    v_mfma_f32_32x32x16_bf16 v[48:63], a[116:119], v[140:143], v[48:63]
    ds_read_b128 v[136:139], v24 offset:36864
    s_waitcnt lgkmcnt(4)
    v_mfma_f32_32x32x16_bf16 v[48:63], a[120:123], v[144:147], v[48:63]
    ds_read_b128 v[140:143], v24 offset:37888
    buffer_load_dwordx4 a[4:7], v2, s[16:19], s54 offen offset:1024 sc1
    v_mul_f32 v80, v32, v32
    v_mul_f32 v81, v33, v33
    v_mul_f32 v82, v34, v34
    v_mfma_f32_32x32x16_bf16 v[48:63], a[124:127], v[148:151], v[48:63]
    ds_read_b128 v[144:147], v24 offset:38912
    v_mul_f32 v83, v35, v35
    v_fma_f32 v80, v80, v14, v13
    v_fma_f32 v81, v81, v14, v13
    v_fma_f32 v82, v82, v14, v13
    v_mfma_f32_32x32x16_bf16 v[48:63], a[128:131], v[120:123], v[48:63]
    ds_read_b128 v[148:151], v24 offset:39936
    buffer_load_dwordx4 a[8:11], v2, s[16:19], s54 offen offset:2048 sc1
    v_fma_f32 v83, v83, v14, v13
    v_mul_f32 v80, v80, v32
    s_waitcnt lgkmcnt(4)
    v_mfma_f32_32x32x16_bf16 v[48:63], a[132:135], v[124:127], v[48:63]
    ds_read_b128 v[120:123], v24 offset:40960
    v_mul_f32 v81, v81, v33
    v_mul_f32 v82, v82, v34
    v_mul_f32 v83, v83, v35
    v_exp_f32 v80, v80
    v_mfma_f32_32x32x16_bf16 v[48:63], a[136:139], v[128:131], v[48:63]
    ds_read_b128 v[124:127], v24 offset:41984
    buffer_load_dwordx4 a[12:15], v2, s[16:19], s54 offen offset:3072 sc1
    s_addk_i32 s54, 4096
    v_mul_f32 v32, v32, v40
    v_mfma_f32_32x32x16_bf16 v[48:63], a[140:143], v[132:135], v[48:63]
    ds_read_b128 v[128:131], v24 offset:43008
    v_exp_f32 v81, v81
    v_mul_f32 v33, v33, v41
    v_exp_f32 v82, v82
    s_waitcnt lgkmcnt(4)
    v_mfma_f32_32x32x16_bf16 v[48:63], a[144:147], v[136:139], v[48:63]
    ds_read_b128 v[132:135], v24 offset:44032
    buffer_load_dwordx4 a[16:19], v2, s[16:19], s54 offen offset:0 sc1
    v_mul_f32 v34, v34, v42
    v_exp_f32 v83, v83
    v_mfma_f32_32x32x16_bf16 v[48:63], a[148:151], v[140:143], v[48:63]
    ds_read_b128 v[136:139], v24 offset:45056
    v_mul_f32 v35, v35, v43
    v_fma_f32 v80, v80, v15, v15
    v_fma_f32 v81, v81, v15, v15
    v_fma_f32 v82, v82, v15, v15
    v_mfma_f32_32x32x16_bf16 v[48:63], a[152:155], v[144:147], v[48:63]
    ds_read_b128 v[140:143], v24 offset:46080
    buffer_load_dwordx4 a[20:23], v2, s[16:19], s54 offen offset:1024 sc1
    v_fma_f32 v83, v83, v15, v15
    s_waitcnt lgkmcnt(4)
    v_mfma_f32_32x32x16_bf16 v[48:63], a[156:159], v[148:151], v[48:63]
    ds_read_b128 v[144:147], v24 offset:47104
    v_rcp_f32 v80, v80
    v_rcp_f32 v81, v81
    v_mul_f32 v32, v32, v80
    v_mfma_f32_32x32x16_bf16 v[48:63], a[160:163], v[120:123], v[48:63]
    ds_read_b128 v[148:151], v24 offset:48128
    buffer_load_dwordx4 a[24:27], v2, s[16:19], s54 offen offset:2048 sc1
    v_rcp_f32 v82, v82
    v_mul_f32 v33, v33, v81
    v_mfma_f32_32x32x16_bf16 v[48:63], a[164:167], v[124:127], v[48:63]
    ds_read_b128 v[120:123], v24 offset:49152
    v_rcp_f32 v83, v83
    v_mul_f32 v34, v34, v82
    v_cvt_pk_bf16_f32 v16, v32, v33
    s_waitcnt lgkmcnt(4)
    v_mfma_f32_32x32x16_bf16 v[48:63], a[168:171], v[128:131], v[48:63]
    ds_read_b128 v[124:127], v24 offset:50176
    buffer_load_dwordx4 a[28:31], v2, s[16:19], s54 offen offset:3072 sc1
    s_addk_i32 s54, 4096
    v_mul_f32 v35, v35, v83
    v_cvt_pk_bf16_f32 v17, v34, v35
    v_mfma_f32_32x32x16_bf16 v[48:63], a[172:175], v[132:135], v[48:63]
    ds_read_b128 v[128:131], v24 offset:51200
    v_mul_f32 v84, v36, v36
    v_mul_f32 v85, v37, v37
    v_mul_f32 v86, v38, v38
    v_mul_f32 v87, v39, v39
    v_fma_f32 v84, v84, v14, v13
    v_mfma_f32_32x32x16_bf16 v[48:63], a[176:179], v[136:139], v[48:63]
    ds_read_b128 v[132:135], v24 offset:52224
    buffer_load_dwordx4 a[32:35], v2, s[16:19], s54 offen offset:0 sc1
    v_fma_f32 v85, v85, v14, v13
    v_fma_f32 v86, v86, v14, v13
    s_waitcnt lgkmcnt(4)
    v_mfma_f32_32x32x16_bf16 v[48:63], a[180:183], v[140:143], v[48:63]
    ds_read_b128 v[136:139], v24 offset:53248
    v_fma_f32 v87, v87, v14, v13
    v_mul_f32 v84, v84, v36
    v_mul_f32 v85, v85, v37
    v_mul_f32 v86, v86, v38
    v_mfma_f32_32x32x16_bf16 v[48:63], a[184:187], v[144:147], v[48:63]
    ds_read_b128 v[140:143], v24 offset:54272
    buffer_load_dwordx4 a[36:39], v2, s[16:19], s54 offen offset:1024 sc1
    v_mul_f32 v87, v87, v39
    v_exp_f32 v84, v84
    v_mfma_f32_32x32x16_bf16 v[48:63], a[188:191], v[148:151], v[48:63]
    ds_read_b128 v[144:147], v24 offset:55296
    v_mul_f32 v36, v36, v44
    v_exp_f32 v85, v85
    v_mul_f32 v37, v37, v45
    s_waitcnt lgkmcnt(4)
    v_mfma_f32_32x32x16_bf16 v[48:63], a[192:195], v[120:123], v[48:63]
    ds_read_b128 v[148:151], v24 offset:56320
    buffer_load_dwordx4 a[40:43], v2, s[16:19], s54 offen offset:2048 sc1
    v_exp_f32 v86, v86
    v_mul_f32 v38, v38, v46
    v_mfma_f32_32x32x16_bf16 v[48:63], a[196:199], v[124:127], v[48:63]
    s_waitcnt vmcnt(10)
    s_addk_i32 s7, 128
    s_mov_b64 exec, 1
    buffer_store_dword v28, off, s[16:19], s7 sc1
    s_mov_b64 exec, -1
    v_mfma_f32_32x32x16_bf16 v[48:63], a[200:203], v[128:131], v[48:63]
    buffer_load_dwordx4 a[44:47], v2, s[16:19], s54 offen offset:3072 sc1
    s_addk_i32 s54, 4096
    v_exp_f32 v87, v87
    s_waitcnt lgkmcnt(2)
    v_mfma_f32_32x32x16_bf16 v[48:63], a[204:207], v[132:135], v[48:63]
    v_mul_f32 v39, v39, v47
    v_fma_f32 v84, v84, v15, v15
    v_fma_f32 v85, v85, v15, v15
    v_fma_f32 v86, v86, v15, v15
    v_fma_f32 v87, v87, v15, v15
    v_mfma_f32_32x32x16_bf16 v[48:63], a[208:211], v[136:139], v[48:63]
    buffer_load_dwordx4 a[48:51], v2, s[16:19], s54 offen offset:0 sc1
    v_rcp_f32 v84, v84
    v_rcp_f32 v85, v85
    v_mul_f32 v36, v36, v84
    v_mfma_f32_32x32x16_bf16 v[48:63], a[212:215], v[140:143], v[48:63]
    v_rcp_f32 v86, v86
    v_mul_f32 v37, v37, v85
    v_rcp_f32 v87, v87
    s_waitcnt lgkmcnt(1)
    v_mfma_f32_32x32x16_bf16 v[48:63], a[216:219], v[144:147], v[48:63]
    buffer_load_dwordx4 a[52:55], v2, s[16:19], s54 offen offset:1024 sc1
    v_mul_f32 v38, v38, v86
    v_cvt_pk_bf16_f32 v18, v36, v37
    v_mul_f32 v39, v39, v87
    v_cvt_pk_bf16_f32 v19, v38, v39
    v_cmp_eq_u32 vcc, -1, v6
    s_nop 0
    s_and_b32 s64, vcc_lo, 0x3fff
    s_cbranch_scc1 L_fhha2_no
L_fhha2_ok:
    s_addk_i32 s53, 128
    s_waitcnt lgkmcnt(0)
    v_mfma_f32_32x32x16_bf16 v[48:63], a[220:223], v[148:151], v[48:63]
    buffer_store_dwordx4 v[16:19], v2, s[16:19], s56 offen sc1
    s_add_u32 s56, s56, 14336
    v_mfma_f32_32x32x16_bf16 v[48:63], v[100:103], v[108:111], v[48:63]
    v_mfma_f32_32x32x16_bf16 v[64:79], v[160:163], a[0:3], 0
    v_mfma_f32_32x32x16_bf16 v[32:47], v[164:167], a[0:3], 0
    buffer_load_dwordx4 a[56:59], v2, s[16:19], s54 offen offset:2048 sc1
    s_waitcnt vmcnt(15)
    v_mfma_f32_32x32x16_bf16 v[64:79], v[168:171], a[4:7], v[64:79]
    s_nop 6
    v_mul_f32 v80, v48, v48
    v_mul_f32 v81, v49, v49
    v_mul_f32 v82, v50, v50
    v_mul_f32 v83, v51, v51
    v_fma_f32 v80, v80, v14, v13
    v_mfma_f32_32x32x16_bf16 v[32:47], v[172:175], a[4:7], v[32:47]
    buffer_load_dwordx4 a[60:63], v2, s[16:19], s54 offen offset:3072 sc1
    s_addk_i32 s54, 4096
    v_fma_f32 v81, v81, v14, v13
    v_fma_f32 v82, v82, v14, v13
    v_fma_f32 v83, v83, v14, v13
    s_waitcnt vmcnt(15)
    v_mfma_f32_32x32x16_bf16 v[64:79], v[176:179], a[8:11], v[64:79]
    v_mul_f32 v80, v80, v48
    v_mul_f32 v81, v81, v49
    v_mul_f32 v82, v82, v50
    v_mul_f32 v83, v83, v51
    v_mfma_f32_32x32x16_bf16 v[32:47], v[180:183], a[8:11], v[32:47]
    buffer_load_dwordx4 a[64:67], v2, s[16:19], s54 offen offset:0 sc1
    v_exp_f32 v80, v80
    v_mul_f32 v48, v48, v56
    v_exp_f32 v81, v81
    s_waitcnt vmcnt(15)
    v_mfma_f32_32x32x16_bf16 v[64:79], v[184:187], a[12:15], v[64:79]
    v_mul_f32 v49, v49, v57
    v_exp_f32 v82, v82
    v_mul_f32 v50, v50, v58
    v_mfma_f32_32x32x16_bf16 v[32:47], v[188:191], a[12:15], v[32:47]
    buffer_load_dwordx4 a[68:71], v2, s[16:19], s54 offen offset:1024 sc1
    v_exp_f32 v83, v83
    v_mul_f32 v51, v51, v59
    v_fma_f32 v80, v80, v15, v15
    s_waitcnt vmcnt(15)
    v_mfma_f32_32x32x16_bf16 v[64:79], v[192:195], a[16:19], v[64:79]
    v_fma_f32 v81, v81, v15, v15
    v_fma_f32 v82, v82, v15, v15
    v_fma_f32 v83, v83, v15, v15
    v_rcp_f32 v80, v80
    v_mfma_f32_32x32x16_bf16 v[32:47], v[196:199], a[16:19], v[32:47]
    buffer_load_dwordx4 a[72:75], v2, s[16:19], s54 offen offset:2048 sc1
    v_rcp_f32 v81, v81
    v_mul_f32 v48, v48, v80
    s_waitcnt vmcnt(15)
    v_mfma_f32_32x32x16_bf16 v[64:79], v[200:203], a[20:23], v[64:79]
    v_rcp_f32 v82, v82
    v_mul_f32 v49, v49, v81
    v_rcp_f32 v83, v83
    v_mfma_f32_32x32x16_bf16 v[32:47], v[204:207], a[20:23], v[32:47]
    buffer_load_dwordx4 a[76:79], v2, s[16:19], s54 offen offset:3072 sc1
    s_addk_i32 s54, 4096
    v_mul_f32 v50, v50, v82
    v_cvt_pk_bf16_f32 v20, v48, v49
    v_mul_f32 v51, v51, v83
    s_waitcnt vmcnt(15)
    v_mfma_f32_32x32x16_bf16 v[64:79], v[208:211], a[24:27], v[64:79]
    v_cvt_pk_bf16_f32 v21, v50, v51
    v_mul_f32 v84, v52, v52
    v_mul_f32 v85, v53, v53
    v_mul_f32 v86, v54, v54
    v_mul_f32 v87, v55, v55
    v_mfma_f32_32x32x16_bf16 v[32:47], v[212:215], a[24:27], v[32:47]
    buffer_load_dwordx4 a[80:83], v2, s[16:19], s54 offen offset:0 sc1
    v_fma_f32 v84, v84, v14, v13
    v_fma_f32 v85, v85, v14, v13
    v_fma_f32 v86, v86, v14, v13
    s_waitcnt vmcnt(15)
    v_mfma_f32_32x32x16_bf16 v[64:79], v[216:219], a[28:31], v[64:79]
    v_fma_f32 v87, v87, v14, v13
    v_mul_f32 v84, v84, v52
    v_mul_f32 v85, v85, v53
    v_mul_f32 v86, v86, v54
    v_mul_f32 v87, v87, v55
    v_mfma_f32_32x32x16_bf16 v[32:47], v[220:223], a[28:31], v[32:47]
    buffer_load_dwordx4 a[84:87], v2, s[16:19], s54 offen offset:1024 sc1
    v_exp_f32 v84, v84
    v_mul_f32 v52, v52, v60
    s_waitcnt vmcnt(15)
    v_mfma_f32_32x32x16_bf16 v[64:79], v[224:227], a[32:35], v[64:79]
    s_mov_b64 exec, 0x3fff
    buffer_load_dword v6, v5, s[16:19], s53 offen sc1
    s_mov_b64 exec, -1
    v_exp_f32 v85, v85
    v_mfma_f32_32x32x16_bf16 v[32:47], v[228:231], a[32:35], v[32:47]
    v_mul_f32 v53, v53, v61
    v_exp_f32 v86, v86
    v_mul_f32 v54, v54, v62
    v_exp_f32 v87, v87
    s_waitcnt vmcnt(15)
    v_mfma_f32_32x32x16_bf16 v[64:79], v[232:235], a[36:39], v[64:79]
    s_addk_i32 s7, 128
    s_mov_b64 exec, 1
    buffer_store_dword v28, off, s[16:19], s7 sc1
    s_mov_b64 exec, -1
    v_mfma_f32_32x32x16_bf16 v[32:47], v[236:239], a[36:39], v[32:47]
    buffer_load_dwordx4 a[88:91], v2, s[16:19], s54 offen offset:2048 sc1
    v_mul_f32 v55, v55, v63
    v_fma_f32 v84, v84, v15, v15
    v_fma_f32 v85, v85, v15, v15
    s_waitcnt vmcnt(16)
    v_mfma_f32_32x32x16_bf16 v[64:79], v[240:243], a[40:43], v[64:79]
    v_fma_f32 v86, v86, v15, v15
    v_fma_f32 v87, v87, v15, v15
    v_rcp_f32 v84, v84
    v_rcp_f32 v85, v85
    v_mfma_f32_32x32x16_bf16 v[32:47], v[244:247], a[40:43], v[32:47]
    buffer_load_dwordx4 a[92:95], v2, s[16:19], s54 offen offset:3072 sc1
    s_addk_i32 s54, 4096
    v_mul_f32 v52, v52, v84
    s_waitcnt vmcnt(15)
    v_mfma_f32_32x32x16_bf16 v[64:79], v[248:251], a[44:47], v[64:79]
    v_rcp_f32 v86, v86
    v_mul_f32 v53, v53, v85
    v_rcp_f32 v87, v87
    v_mul_f32 v54, v54, v86
    v_mfma_f32_32x32x16_bf16 v[32:47], v[252:255], a[44:47], v[32:47]
    buffer_load_dwordx4 a[96:99], v2, s[16:19], s54 offen offset:0 sc1
    v_cvt_pk_bf16_f32 v22, v52, v53
    v_mul_f32 v55, v55, v87
    v_cvt_pk_bf16_f32 v23, v54, v55
    s_waitcnt vmcnt(15)
    v_mfma_f32_32x32x16_bf16 v[64:79], a[224:227], a[48:51], v[64:79]
    buffer_store_dwordx4 v[20:23], v2, s[16:19], s56 offen sc1
    s_add_u32 s56, s56, 100352
    ds_read_b64_tr_b16 a[112:113], v156 offset:4096
    ds_read_b64_tr_b16 a[114:115], v156 offset:4608
    v_mfma_f32_32x32x16_bf16 v[32:47], a[228:231], a[48:51], v[32:47]
    ds_read_b64_tr_b16 a[116:117], v157 offset:4096
    ds_read_b64_tr_b16 a[118:119], v157 offset:4608
    s_waitcnt vmcnt(15)
    v_mfma_f32_32x32x16_bf16 v[64:79], a[232:235], a[52:55], v[64:79]
    ds_read_b64_tr_b16 a[120:121], v156 offset:6144
    ds_read_b64_tr_b16 a[122:123], v156 offset:6656
    v_mfma_f32_32x32x16_bf16 v[32:47], a[236:239], a[52:55], v[32:47]
    buffer_load_dwordx4 a[100:103], v2, s[16:19], s54 offen offset:1024 sc1
    ds_read_b64_tr_b16 a[124:125], v157 offset:6144
    ds_read_b64_tr_b16 a[126:127], v157 offset:6656
    s_waitcnt vmcnt(14)
    v_mfma_f32_32x32x16_bf16 v[64:79], a[240:243], a[56:59], v[64:79]
    ds_read_b64_tr_b16 a[128:129], v156 offset:0
    ds_read_b64_tr_b16 a[130:131], v156 offset:512
    v_mfma_f32_32x32x16_bf16 v[32:47], a[244:247], a[56:59], v[32:47]
    buffer_load_dwordx4 a[104:107], v2, s[16:19], s54 offen offset:2048 sc1
    ds_read_b64_tr_b16 a[132:133], v157 offset:0
    ds_read_b64_tr_b16 a[134:135], v157 offset:512
    s_waitcnt vmcnt(14)
    v_mfma_f32_32x32x16_bf16 v[64:79], a[248:251], a[60:63], v[64:79]
    ds_read_b64_tr_b16 a[136:137], v156 offset:2048
    ds_read_b64_tr_b16 a[138:139], v156 offset:2560
    v_mfma_f32_32x32x16_bf16 v[32:47], a[252:255], a[60:63], v[32:47]
    buffer_load_dwordx4 a[108:111], v2, s[16:19], s54 offen offset:3072 sc1
    s_add_u32 s54, s54, 204800
    ds_read_b64_tr_b16 a[140:141], v157 offset:2048
    ds_read_b64_tr_b16 a[142:143], v157 offset:2560
    s_waitcnt vmcnt(14) lgkmcnt(14)
    v_mfma_f32_32x32x16_bf16 v[64:79], a[112:115], a[64:67], v[64:79]
    ds_read_b64_tr_b16 a[144:145], v158 offset:0
    ds_read_b64_tr_b16 a[146:147], v158 offset:512
    s_waitcnt lgkmcnt(14)
    v_mfma_f32_32x32x16_bf16 v[32:47], a[116:119], a[64:67], v[32:47]
    buffer_load_dwordx4 v[132:135], v118, s[16:19], s71 offen sc1
    ds_read_b64_tr_b16 a[148:149], v159 offset:0
    ds_read_b64_tr_b16 a[150:151], v159 offset:512
    s_waitcnt vmcnt(14) lgkmcnt(14)
    v_mfma_f32_32x32x16_bf16 v[64:79], a[120:123], a[68:71], v[64:79]
    ds_read_b64_tr_b16 a[152:153], v158 offset:2048
    ds_read_b64_tr_b16 a[154:155], v158 offset:2560
    s_add_u32 s71, s71, 57344
    s_waitcnt lgkmcnt(14)
    v_mfma_f32_32x32x16_bf16 v[32:47], a[124:127], a[68:71], v[32:47]
    buffer_load_dwordx4 v[136:139], v118, s[16:19], s71 offen sc1
    ds_read_b64_tr_b16 a[156:157], v159 offset:2048
    ds_read_b64_tr_b16 a[158:159], v159 offset:2560
    s_waitcnt vmcnt(10)
    v_cmp_eq_u32 vcc, -1, v6
    s_nop 0
    s_and_b32 s64, vcc_lo, 0x3fff
    s_cbranch_scc1 L_fhhb_no
L_fhhb_ok:
    s_addk_i32 s53, 128
    s_waitcnt lgkmcnt(14)
    v_mfma_f32_32x32x16_bf16 v[64:79], a[128:131], a[72:75], v[64:79]
    ds_read_b64_tr_b16 a[160:161], v158 offset:16384
    ds_read_b64_tr_b16 a[162:163], v158 offset:16896
    s_waitcnt lgkmcnt(14)
    v_mfma_f32_32x32x16_bf16 v[32:47], a[132:135], a[72:75], v[32:47]
    buffer_load_dwordx4 a[0:3], v2, s[16:19], s54 offen offset:0 sc1
    ds_read_b64_tr_b16 a[164:165], v159 offset:16384
    ds_read_b64_tr_b16 a[166:167], v159 offset:16896
    s_waitcnt lgkmcnt(14)
    v_mfma_f32_32x32x16_bf16 v[64:79], a[136:139], a[76:79], v[64:79]
    ds_read_b64_tr_b16 a[168:169], v158 offset:18432
    ds_read_b64_tr_b16 a[170:171], v158 offset:18944
    s_waitcnt lgkmcnt(14)
    v_mfma_f32_32x32x16_bf16 v[32:47], a[140:143], a[76:79], v[32:47]
    buffer_load_dwordx4 a[4:7], v2, s[16:19], s54 offen offset:1024 sc1
    ds_read_b64_tr_b16 a[172:173], v159 offset:18432
    ds_read_b64_tr_b16 a[174:175], v159 offset:18944
    s_waitcnt lgkmcnt(14)
    v_mfma_f32_32x32x16_bf16 v[64:79], a[144:147], a[80:83], v[64:79]
    ds_read_b64_tr_b16 a[176:177], v158 offset:32768
    ds_read_b64_tr_b16 a[178:179], v158 offset:33280
    s_waitcnt lgkmcnt(14)
    v_mfma_f32_32x32x16_bf16 v[32:47], a[148:151], a[80:83], v[32:47]
    buffer_load_dwordx4 a[8:11], v2, s[16:19], s54 offen offset:2048 sc1
    ds_read_b64_tr_b16 a[180:181], v159 offset:32768
    ds_read_b64_tr_b16 a[182:183], v159 offset:33280
    s_waitcnt lgkmcnt(14)
    v_mfma_f32_32x32x16_bf16 v[64:79], a[152:155], a[84:87], v[64:79]
    ds_read_b64_tr_b16 a[184:185], v158 offset:34816
    ds_read_b64_tr_b16 a[186:187], v158 offset:35328
    s_waitcnt lgkmcnt(14)
    v_mfma_f32_32x32x16_bf16 v[32:47], a[156:159], a[84:87], v[32:47]
    buffer_load_dwordx4 a[12:15], v2, s[16:19], s54 offen offset:3072 sc1
    s_addk_i32 s54, 4096
    ds_read_b64_tr_b16 a[188:189], v159 offset:34816
    ds_read_b64_tr_b16 a[190:191], v159 offset:35328
    s_waitcnt vmcnt(12) lgkmcnt(14)
    v_mfma_f32_32x32x16_bf16 v[64:79], a[160:163], a[88:91], v[64:79]
    ds_read_b64_tr_b16 a[192:193], v158 offset:49152
    ds_read_b64_tr_b16 a[194:195], v158 offset:49664
    s_waitcnt lgkmcnt(14)
    v_mfma_f32_32x32x16_bf16 v[32:47], a[164:167], a[88:91], v[32:47]
    buffer_load_dwordx4 a[16:19], v2, s[16:19], s54 offen offset:0 sc1
    ds_read_b64_tr_b16 a[196:197], v159 offset:49152
    ds_read_b64_tr_b16 a[198:199], v159 offset:49664
    s_waitcnt vmcnt(12) lgkmcnt(14)
    v_mfma_f32_32x32x16_bf16 v[64:79], a[168:171], a[92:95], v[64:79]
    ds_read_b64_tr_b16 a[200:201], v158 offset:51200
    ds_read_b64_tr_b16 a[202:203], v158 offset:51712
    s_waitcnt lgkmcnt(14)
    v_mfma_f32_32x32x16_bf16 v[32:47], a[172:175], a[92:95], v[32:47]
    buffer_load_dwordx4 a[20:23], v2, s[16:19], s54 offen offset:1024 sc1
    ds_read_b64_tr_b16 a[204:205], v159 offset:51200
    ds_read_b64_tr_b16 a[206:207], v159 offset:51712
    s_waitcnt vmcnt(12) lgkmcnt(14)
    v_mfma_f32_32x32x16_bf16 v[64:79], a[176:179], a[96:99], v[64:79]
    s_mov_b64 exec, 0x3fff
    buffer_load_dword v6, v5, s[16:19], s53 offen sc1
    s_mov_b64 exec, -1
    s_waitcnt lgkmcnt(12)
    v_mfma_f32_32x32x16_bf16 v[32:47], a[180:183], a[96:99], v[32:47]
    s_waitcnt vmcnt(11) lgkmcnt(10)
    v_mfma_f32_32x32x16_bf16 v[64:79], a[184:187], a[100:103], v[64:79]
    buffer_load_dwordx4 a[24:27], v2, s[16:19], s54 offen offset:2048 sc1
    s_barrier
    s_waitcnt lgkmcnt(8)
    v_mfma_f32_32x32x16_bf16 v[32:47], a[188:191], a[100:103], v[32:47]
    s_waitcnt vmcnt(11) lgkmcnt(6)
    v_mfma_f32_32x32x16_bf16 v[64:79], a[192:195], a[104:107], v[64:79]
    buffer_load_dwordx4 a[28:31], v2, s[16:19], s54 offen offset:3072 sc1
    s_addk_i32 s54, 4096
    s_waitcnt lgkmcnt(4)
    v_mfma_f32_32x32x16_bf16 v[32:47], a[196:199], a[104:107], v[32:47]
    s_waitcnt vmcnt(11) lgkmcnt(2)
    v_mfma_f32_32x32x16_bf16 v[64:79], a[200:203], a[108:111], v[64:79]
    buffer_load_dwordx4 a[32:35], v2, s[16:19], s54 offen offset:0 sc1
    s_waitcnt lgkmcnt(0)
    v_mfma_f32_32x32x16_bf16 v[32:47], a[204:207], a[108:111], v[32:47]
    s_waitcnt vmcnt(9)
    v_mfma_f32_32x32x16_bf16 v[80:95], v[160:163], a[0:3], 0
    buffer_load_dwordx4 a[36:39], v2, s[16:19], s54 offen offset:1024 sc1
    v_accvgpr_read_b32 v153, a0
    v_mfma_f32_32x32x16_bf16 v[48:63], v[164:167], a[0:3], 0
    s_waitcnt vmcnt(9)
    v_mfma_f32_32x32x16_bf16 v[80:95], v[168:171], a[4:7], v[80:95]
    buffer_load_dwordx4 a[40:43], v2, s[16:19], s54 offen offset:2048 sc1
    s_nop 0
    ds_write_b128 v119, v[64:67] offset:0
    v_accvgpr_read_b32 v154, a4
    v_max3_u32 v152, v153, v153, v154
    v_mfma_f32_32x32x16_bf16 v[48:63], v[172:175], a[4:7], v[48:63]
    ds_write_b128 v119, v[68:71] offset:1152
    s_waitcnt vmcnt(9)
    v_mfma_f32_32x32x16_bf16 v[80:95], v[176:179], a[8:11], v[80:95]
    buffer_load_dwordx4 a[44:47], v2, s[16:19], s54 offen offset:3072 sc1
    s_addk_i32 s54, 4096
    v_accvgpr_read_b32 v153, a8
    v_mfma_f32_32x32x16_bf16 v[48:63], v[180:183], a[8:11], v[48:63]
    ds_write_b128 v119, v[72:75] offset:2432
    s_waitcnt vmcnt(9)
    v_mfma_f32_32x32x16_bf16 v[80:95], v[184:187], a[12:15], v[80:95]
    buffer_load_dwordx4 a[48:51], v2, s[16:19], s54 offen offset:0 sc1
    v_accvgpr_read_b32 v154, a12
    v_max3_u32 v152, v152, v153, v154
    v_mfma_f32_32x32x16_bf16 v[48:63], v[188:191], a[12:15], v[48:63]
    ds_write_b128 v119, v[76:79] offset:3584
    s_waitcnt vmcnt(9)
    v_mfma_f32_32x32x16_bf16 v[80:95], v[192:195], a[16:19], v[80:95]
    buffer_load_dwordx4 a[52:55], v2, s[16:19], s54 offen offset:1024 sc1
    v_accvgpr_read_b32 v153, a16
    v_mfma_f32_32x32x16_bf16 v[48:63], v[196:199], a[16:19], v[48:63]
    ds_write_b128 v119, v[32:35] offset:4864
    s_waitcnt vmcnt(8)
    v_cmp_eq_u32 vcc, -1, v6
    s_nop 0
    s_and_b32 s64, vcc_lo, 0x3fff
    s_cbranch_scc1 L_fhhc_no
L_fhhc_ok:
    s_addk_i32 s53, 128
    v_mfma_f32_32x32x16_bf16 v[80:95], v[200:203], a[20:23], v[80:95]
    buffer_load_dwordx4 a[56:59], v2, s[16:19], s54 offen offset:2048 sc1
    ds_write_b128 v119, v[36:39] offset:6016
    v_accvgpr_read_b32 v154, a20
    v_max3_u32 v152, v152, v153, v154
    v_mfma_f32_32x32x16_bf16 v[48:63], v[204:207], a[20:23], v[48:63]
    s_waitcnt vmcnt(8)
    v_mfma_f32_32x32x16_bf16 v[80:95], v[208:211], a[24:27], v[80:95]
    buffer_load_dwordx4 a[60:63], v2, s[16:19], s54 offen offset:3072 sc1
    s_addk_i32 s54, 4096
    ds_write_b128 v119, v[40:43] offset:7296
    v_accvgpr_read_b32 v153, a24
    v_mfma_f32_32x32x16_bf16 v[48:63], v[212:215], a[24:27], v[48:63]
    s_waitcnt vmcnt(8)
    v_mfma_f32_32x32x16_bf16 v[80:95], v[216:219], a[28:31], v[80:95]
    buffer_load_dwordx4 a[64:67], v2, s[16:19], s54 offen offset:0 sc1
    ds_write_b128 v119, v[44:47] offset:8448
    v_accvgpr_read_b32 v154, a28
    v_max3_u32 v152, v152, v153, v154
    v_mfma_f32_32x32x16_bf16 v[48:63], v[220:223], a[28:31], v[48:63]
    s_waitcnt vmcnt(8)
    v_mfma_f32_32x32x16_bf16 v[80:95], v[224:227], a[32:35], v[80:95]
    buffer_load_dwordx4 a[68:71], v2, s[16:19], s54 offen offset:1024 sc1
    v_accvgpr_read_b32 v153, a32
    v_mfma_f32_32x32x16_bf16 v[48:63], v[228:231], a[32:35], v[48:63]
    s_waitcnt vmcnt(8)
    v_mfma_f32_32x32x16_bf16 v[80:95], v[232:235], a[36:39], v[80:95]
    buffer_load_dwordx4 a[72:75], v2, s[16:19], s54 offen offset:2048 sc1
    v_accvgpr_read_b32 v154, a36
    v_max3_u32 v152, v152, v153, v154
    s_waitcnt lgkmcnt(0)
    s_barrier
    v_mfma_f32_32x32x16_bf16 v[48:63], v[236:239], a[36:39], v[48:63]
    ds_read_b128 v[96:99], v116 offset:0
    s_waitcnt vmcnt(8)
    v_mfma_f32_32x32x16_bf16 v[80:95], v[240:243], a[40:43], v[80:95]
    buffer_load_dwordx4 a[76:79], v2, s[16:19], s54 offen offset:3072 sc1
    s_addk_i32 s54, 4096
    ds_read_b128 v[100:103], v116 offset:1152
    v_accvgpr_read_b32 v153, a40
    v_mfma_f32_32x32x16_bf16 v[48:63], v[244:247], a[40:43], v[48:63]
    ds_read_b128 v[104:107], v116 offset:9728
    s_waitcnt vmcnt(8)
    v_mfma_f32_32x32x16_bf16 v[80:95], v[248:251], a[44:47], v[80:95]
    buffer_load_dwordx4 a[80:83], v2, s[16:19], s54 offen offset:0 sc1
    ds_read_b128 v[108:111], v116 offset:10880
    v_accvgpr_read_b32 v154, a44
    v_max3_u32 v152, v152, v153, v154
    v_mfma_f32_32x32x16_bf16 v[48:63], v[252:255], a[44:47], v[48:63]
    ds_read_b128 v[120:123], v116 offset:19456
    s_waitcnt vmcnt(8)
    v_mfma_f32_32x32x16_bf16 v[80:95], a[224:227], a[48:51], v[80:95]
    buffer_load_dwordx4 a[84:87], v2, s[16:19], s54 offen offset:1024 sc1
    ds_read_b128 v[124:127], v116 offset:20608
    v_accvgpr_read_b32 v153, a48
    v_mfma_f32_32x32x16_bf16 v[48:63], a[228:231], a[48:51], v[48:63]
    ds_read_b128 v[8:11], v116 offset:29184
    s_waitcnt vmcnt(8)
    v_mfma_f32_32x32x16_bf16 v[80:95], a[232:235], a[52:55], v[80:95]
    buffer_load_dwordx4 a[88:91], v2, s[16:19], s54 offen offset:2048 sc1
    ds_read_b128 v[12:15], v116 offset:30336
    v_accvgpr_read_b32 v154, a52
    v_max3_u32 v152, v152, v153, v154
    v_mfma_f32_32x32x16_bf16 v[48:63], a[236:239], a[52:55], v[48:63]
    s_waitcnt vmcnt(8)
    v_mfma_f32_32x32x16_bf16 v[80:95], a[240:243], a[56:59], v[80:95]
    buffer_load_dwordx4 a[92:95], v2, s[16:19], s54 offen offset:3072 sc1
    s_addk_i32 s54, 4096
    v_accvgpr_read_b32 v153, a56
    v_mfma_f32_32x32x16_bf16 v[48:63], a[244:247], a[56:59], v[48:63]
    v_lshlrev_b32 v144, 16, v132
    v_and_b32 v145, s4, v132
    v_lshlrev_b32 v146, 16, v133
    v_and_b32 v147, s4, v133
    s_waitcnt vmcnt(8)
    v_mfma_f32_32x32x16_bf16 v[80:95], a[248:251], a[60:63], v[80:95]
    buffer_load_dwordx4 a[96:99], v2, s[16:19], s54 offen offset:0 sc1
    v_accvgpr_read_b32 v154, a60
    v_max3_u32 v152, v152, v153, v154
    v_mfma_f32_32x32x16_bf16 v[48:63], a[252:255], a[60:63], v[48:63]
    v_lshlrev_b32 v148, 16, v134
    v_and_b32 v149, s4, v134
    v_lshlrev_b32 v150, 16, v135
    v_and_b32 v151, s4, v135
    s_waitcnt vmcnt(8)
    v_mfma_f32_32x32x16_bf16 v[80:95], a[112:115], a[64:67], v[80:95]
    buffer_load_dwordx4 a[100:103], v2, s[16:19], s54 offen offset:1024 sc1
    v_accvgpr_read_b32 v153, a64
    s_waitcnt lgkmcnt(7)
    v_add_f32 v144, v144, v96
    v_mfma_f32_32x32x16_bf16 v[48:63], a[116:119], a[64:67], v[48:63]
    v_add_f32 v145, v145, v97
    v_add_f32 v146, v146, v98
    v_add_f32 v147, v147, v99
    s_waitcnt lgkmcnt(6)
    v_add_f32 v148, v148, v100
    s_waitcnt vmcnt(8)
    v_mfma_f32_32x32x16_bf16 v[80:95], a[120:123], a[68:71], v[80:95]
    buffer_load_dwordx4 a[104:107], v2, s[16:19], s54 offen offset:2048 sc1
    v_accvgpr_read_b32 v154, a68
    v_max3_u32 v152, v152, v153, v154
    v_mfma_f32_32x32x16_bf16 v[48:63], a[124:127], a[68:71], v[48:63]
    v_add_f32 v149, v149, v101
    v_add_f32 v150, v150, v102
    v_add_f32 v151, v151, v103
    s_waitcnt lgkmcnt(5)
    v_add_f32 v144, v144, v104
    s_waitcnt vmcnt(8)
    v_mfma_f32_32x32x16_bf16 v[80:95], a[128:131], a[72:75], v[80:95]
    buffer_load_dwordx4 a[108:111], v2, s[16:19], s54 offen offset:3072 sc1
    s_sub_u32 s54, s54, 24576
    v_accvgpr_read_b32 v153, a72
    v_mfma_f32_32x32x16_bf16 v[48:63], a[132:135], a[72:75], v[48:63]
    v_add_f32 v145, v145, v105
    v_add_f32 v146, v146, v106
    v_add_f32 v147, v147, v107
    s_waitcnt lgkmcnt(4)
    v_add_f32 v148, v148, v108
    s_waitcnt vmcnt(8)
    v_mfma_f32_32x32x16_bf16 v[80:95], a[136:139], a[76:79], v[80:95]
    v_accvgpr_read_b32 v154, a76
    v_max3_u32 v152, v152, v153, v154
    v_add_f32 v149, v149, v109
    v_add_f32 v150, v150, v110
    v_mfma_f32_32x32x16_bf16 v[48:63], a[140:143], a[76:79], v[48:63]
    v_add_f32 v151, v151, v111
    s_waitcnt lgkmcnt(3)
    v_add_f32 v144, v144, v120
    v_add_f32 v145, v145, v121
    v_add_f32 v146, v146, v122
    s_waitcnt vmcnt(7)
    v_mfma_f32_32x32x16_bf16 v[80:95], a[144:147], a[80:83], v[80:95]
    v_accvgpr_read_b32 v153, a80
    v_add_f32 v147, v147, v123
    s_waitcnt lgkmcnt(2)
    v_add_f32 v148, v148, v124
    v_add_f32 v149, v149, v125
    v_mfma_f32_32x32x16_bf16 v[48:63], a[148:151], a[80:83], v[48:63]
    v_add_f32 v150, v150, v126
    v_add_f32 v151, v151, v127
    s_waitcnt lgkmcnt(1)
    v_add_f32 v144, v144, v8
    v_add_f32 v145, v145, v9
    s_waitcnt vmcnt(6)
    v_mfma_f32_32x32x16_bf16 v[80:95], a[152:155], a[84:87], v[80:95]
    v_accvgpr_read_b32 v154, a84
    v_max3_u32 v152, v152, v153, v154
    v_add_f32 v146, v146, v10
    v_add_f32 v147, v147, v11
    v_mfma_f32_32x32x16_bf16 v[48:63], a[156:159], a[84:87], v[48:63]
    s_waitcnt lgkmcnt(0)
    v_add_f32 v148, v148, v12
    v_add_f32 v149, v149, v13
    v_add_f32 v150, v150, v14
    v_add_f32 v151, v151, v15
    s_waitcnt vmcnt(5)
    v_mfma_f32_32x32x16_bf16 v[80:95], a[160:163], a[88:91], v[80:95]
    v_accvgpr_read_b32 v153, a88
    v_cvt_pk_bf16_f32 v16, v144, v145
    v_cvt_pk_bf16_f32 v17, v146, v147
    v_cvt_pk_bf16_f32 v18, v148, v149
    v_mfma_f32_32x32x16_bf16 v[48:63], a[164:167], a[88:91], v[48:63]
    v_cvt_pk_bf16_f32 v19, v150, v151
    buffer_store_dwordx4 v[16:19], v117, s[36:39], s72 offen sc1
    s_add_u32 s72, s72, 57344
    s_waitcnt vmcnt(5)
    v_mfma_f32_32x32x16_bf16 v[80:95], a[168:171], a[92:95], v[80:95]
    s_barrier
    v_accvgpr_read_b32 v154, a92
    v_max3_u32 v152, v152, v153, v154
    s_waitcnt vmcnt(4)
    v_mfma_f32_32x32x16_bf16 v[80:95], a[176:179], a[96:99], v[80:95]
    v_accvgpr_read_b32 v153, a96
    s_waitcnt vmcnt(3)
    v_mfma_f32_32x32x16_bf16 v[80:95], a[184:187], a[100:103], v[80:95]
    v_accvgpr_read_b32 v154, a100
    v_max3_u32 v152, v152, v153, v154
    s_waitcnt vmcnt(2)
    v_mfma_f32_32x32x16_bf16 v[80:95], a[192:195], a[104:107], v[80:95]
    v_accvgpr_read_b32 v153, a104
    s_waitcnt vmcnt(1)
    v_mfma_f32_32x32x16_bf16 v[80:95], a[200:203], a[108:111], v[80:95]
    v_accvgpr_read_b32 v154, a108
    v_max3_u32 v152, v152, v153, v154
    v_cmp_eq_u32 vcc, -1, v152
    s_nop 0
    s_cmp_lg_u64 vcc, 0
    s_cbranch_scc1 L_redo
    v_mfma_f32_32x32x16_bf16 v[48:63], a[172:175], a[92:95], v[48:63]
    v_mfma_f32_32x32x16_bf16 v[48:63], a[180:183], a[96:99], v[48:63]
    s_nop 3
    ds_write_b128 v119, v[80:83] offset:0
    v_mfma_f32_32x32x16_bf16 v[48:63], a[188:191], a[100:103], v[48:63]
    ds_write_b128 v119, v[84:87] offset:1152
    v_mfma_f32_32x32x16_bf16 v[48:63], a[196:199], a[104:107], v[48:63]
    ds_write_b128 v119, v[88:91] offset:2432
    v_mfma_f32_32x32x16_bf16 v[48:63], a[204:207], a[108:111], v[48:63]
    ds_write_b128 v119, v[92:95] offset:3584
    v_lshlrev_b32 v144, 16, v136
    v_and_b32 v145, s4, v136
    v_lshlrev_b32 v146, 16, v137
    v_and_b32 v147, s4, v137
    v_lshlrev_b32 v148, 16, v138
    v_and_b32 v149, s4, v138
    v_lshlrev_b32 v150, 16, v139
    v_and_b32 v151, s4, v139
    s_nop 2
    ds_write_b128 v119, v[48:51] offset:4864
    ds_write_b128 v119, v[52:55] offset:6016
    ds_write_b128 v119, v[56:59] offset:7296
    ds_write_b128 v119, v[60:63] offset:8448
L_redone:
    s_waitcnt lgkmcnt(0)
    s_barrier
    ds_read_b128 v[96:99], v116 offset:0
    ds_read_b128 v[100:103], v116 offset:1152
    ds_read_b128 v[104:107], v116 offset:9728
    ds_read_b128 v[108:111], v116 offset:10880
    ds_read_b128 v[120:123], v116 offset:19456
    ds_read_b128 v[124:127], v116 offset:20608
    ds_read_b128 v[8:11], v116 offset:29184
    ds_read_b128 v[12:15], v116 offset:30336
    s_waitcnt lgkmcnt(7)
    v_pk_add_f32 v[144:145], v[144:145], v[96:97]
    v_pk_add_f32 v[146:147], v[146:147], v[98:99]
    s_waitcnt lgkmcnt(6)
    v_pk_add_f32 v[148:149], v[148:149], v[100:101]
    v_pk_add_f32 v[150:151], v[150:151], v[102:103]
    s_waitcnt lgkmcnt(5)
    v_pk_add_f32 v[144:145], v[144:145], v[104:105]
    v_pk_add_f32 v[146:147], v[146:147], v[106:107]
    s_waitcnt lgkmcnt(4)
    v_pk_add_f32 v[148:149], v[148:149], v[108:109]
    v_pk_add_f32 v[150:151], v[150:151], v[110:111]
    s_waitcnt lgkmcnt(3)
    v_pk_add_f32 v[144:145], v[144:145], v[120:121]
    v_pk_add_f32 v[146:147], v[146:147], v[122:123]
    s_waitcnt lgkmcnt(2)
    v_pk_add_f32 v[148:149], v[148:149], v[124:125]
    v_pk_add_f32 v[150:151], v[150:151], v[126:127]
    s_waitcnt lgkmcnt(1)
    v_pk_add_f32 v[144:145], v[144:145], v[8:9]
    v_pk_add_f32 v[146:147], v[146:147], v[10:11]
    s_waitcnt lgkmcnt(0)
    v_pk_add_f32 v[148:149], v[148:149], v[12:13]
    v_pk_add_f32 v[150:151], v[150:151], v[14:15]
    v_cvt_pk_bf16_f32 v20, v144, v145
    v_cvt_pk_bf16_f32 v21, v146, v147
    v_cvt_pk_bf16_f32 v22, v148, v149
    v_cvt_pk_bf16_f32 v23, v150, v151
    buffer_store_dwordx4 v[20:23], v117, s[36:39], s72 offen sc1
    s_endpgm
L_fhha_no:
    s_mov_b32 exec_lo, 0x3fff
    s_mov_b32 exec_hi, 0x0
    s_movk_i32 s66, 0x4000
L_fhha_3:
    buffer_load_dword v7, v5, s[16:19], s53 offen sc1
    s_waitcnt vmcnt(0)
    v_cmp_eq_u32 vcc, -1, v7
    s_sub_u32 s66, s66, 1
    s_cbranch_scc1 L_fhhad_4
    s_and_b64 exec, vcc, exec
    s_cbranch_scc1 L_fhha_3
L_fhhad_4:
    s_mov_b64 exec, -1
    s_branch L_fhha_ok
L_fhha2_no:
    s_mov_b32 exec_lo, 0x3fff
    s_mov_b32 exec_hi, 0x0
    s_movk_i32 s66, 0x4000
L_fhha2_5:
    buffer_load_dword v7, v5, s[16:19], s53 offen sc1
    s_waitcnt vmcnt(0)
    v_cmp_eq_u32 vcc, -1, v7
    s_sub_u32 s66, s66, 1
    s_cbranch_scc1 L_fhha2d_6
    s_and_b64 exec, vcc, exec
    s_cbranch_scc1 L_fhha2_5
L_fhha2d_6:
    s_mov_b64 exec, -1
    s_branch L_fhha2_ok
L_fhhb_no:
    s_mov_b32 exec_lo, 0x3fff
    s_mov_b32 exec_hi, 0x0
    s_movk_i32 s66, 0x4000
L_fhhb_7:
    buffer_load_dword v7, v5, s[16:19], s53 offen sc1
    s_waitcnt vmcnt(0)
    v_cmp_eq_u32 vcc, -1, v7
    s_sub_u32 s66, s66, 1
    s_cbranch_scc1 L_fhhbd_8
    s_and_b64 exec, vcc, exec
    s_cbranch_scc1 L_fhhb_7
L_fhhbd_8:
    s_mov_b64 exec, -1
    s_branch L_fhhb_ok
L_fhhc_no:
    s_mov_b32 exec_lo, 0x3fff
    s_mov_b32 exec_hi, 0x0
    s_movk_i32 s66, 0x4000
L_fhhc_9:
    buffer_load_dword v7, v5, s[16:19], s53 offen sc1
    s_waitcnt vmcnt(0)
    v_cmp_eq_u32 vcc, -1, v7
    s_sub_u32 s66, s66, 1
    s_cbranch_scc1 L_fhhcd_10
    s_and_b64 exec, vcc, exec
    s_cbranch_scc1 L_fhhc_9
L_fhhcd_10:
    s_mov_b64 exec, -1
    s_branch L_fhhc_ok
L_redo:
    s_movk_i32 s66, 0x1000
L_redo1:
    buffer_load_dwordx4 a[0:3], v2, s[16:19], s54 offen offset:0 sc1
    buffer_load_dwordx4 a[4:7], v2, s[16:19], s54 offen offset:1024 sc1
    buffer_load_dwordx4 a[8:11], v2, s[16:19], s54 offen offset:2048 sc1
    buffer_load_dwordx4 a[12:15], v2, s[16:19], s54 offen offset:3072 sc1
    s_addk_i32 s54, 4096
    buffer_load_dwordx4 a[16:19], v2, s[16:19], s54 offen offset:0 sc1
    buffer_load_dwordx4 a[20:23], v2, s[16:19], s54 offen offset:1024 sc1
    buffer_load_dwordx4 a[24:27], v2, s[16:19], s54 offen offset:2048 sc1
    buffer_load_dwordx4 a[28:31], v2, s[16:19], s54 offen offset:3072 sc1
    s_addk_i32 s54, 4096
    buffer_load_dwordx4 a[32:35], v2, s[16:19], s54 offen offset:0 sc1
    buffer_load_dwordx4 a[36:39], v2, s[16:19], s54 offen offset:1024 sc1
    buffer_load_dwordx4 a[40:43], v2, s[16:19], s54 offen offset:2048 sc1
    buffer_load_dwordx4 a[44:47], v2, s[16:19], s54 offen offset:3072 sc1
    s_addk_i32 s54, 4096
    buffer_load_dwordx4 a[48:51], v2, s[16:19], s54 offen offset:0 sc1
    buffer_load_dwordx4 a[52:55], v2, s[16:19], s54 offen offset:1024 sc1
    buffer_load_dwordx4 a[56:59], v2, s[16:19], s54 offen offset:2048 sc1
    buffer_load_dwordx4 a[60:63], v2, s[16:19], s54 offen offset:3072 sc1
    s_addk_i32 s54, 4096
    buffer_load_dwordx4 a[64:67], v2, s[16:19], s54 offen offset:0 sc1
    buffer_load_dwordx4 a[68:71], v2, s[16:19], s54 offen offset:1024 sc1
    buffer_load_dwordx4 a[72:75], v2, s[16:19], s54 offen offset:2048 sc1
    buffer_load_dwordx4 a[76:79], v2, s[16:19], s54 offen offset:3072 sc1
    s_addk_i32 s54, 4096
    buffer_load_dwordx4 a[80:83], v2, s[16:19], s54 offen offset:0 sc1
    buffer_load_dwordx4 a[84:87], v2, s[16:19], s54 offen offset:1024 sc1
    buffer_load_dwordx4 a[88:91], v2, s[16:19], s54 offen offset:2048 sc1
    buffer_load_dwordx4 a[92:95], v2, s[16:19], s54 offen offset:3072 sc1
    s_addk_i32 s54, 4096
    buffer_load_dwordx4 a[96:99], v2, s[16:19], s54 offen offset:0 sc1
    buffer_load_dwordx4 a[100:103], v2, s[16:19], s54 offen offset:1024 sc1
    buffer_load_dwordx4 a[104:107], v2, s[16:19], s54 offen offset:2048 sc1
    buffer_load_dwordx4 a[108:111], v2, s[16:19], s54 offen offset:3072 sc1
    s_sub_u32 s54, s54, 24576
    s_waitcnt vmcnt(27)
    v_accvgpr_read_b32 v153, a0
    s_waitcnt vmcnt(26)
    v_accvgpr_read_b32 v154, a4
    v_max3_u32 v152, v153, v153, v154
    s_waitcnt vmcnt(25)
    v_accvgpr_read_b32 v153, a8
    s_waitcnt vmcnt(24)
    v_accvgpr_read_b32 v154, a12
    v_max3_u32 v152, v152, v153, v154
    s_waitcnt vmcnt(23)
    v_accvgpr_read_b32 v153, a16
    s_waitcnt vmcnt(22)
    v_accvgpr_read_b32 v154, a20
    v_max3_u32 v152, v152, v153, v154
    s_waitcnt vmcnt(21)
    v_accvgpr_read_b32 v153, a24
    s_waitcnt vmcnt(20)
    v_accvgpr_read_b32 v154, a28
    v_max3_u32 v152, v152, v153, v154
    s_waitcnt vmcnt(19)
    v_accvgpr_read_b32 v153, a32
    s_waitcnt vmcnt(18)
    v_accvgpr_read_b32 v154, a36
    v_max3_u32 v152, v152, v153, v154
    s_waitcnt vmcnt(17)
    v_accvgpr_read_b32 v153, a40
    s_waitcnt vmcnt(16)
    v_accvgpr_read_b32 v154, a44
    v_max3_u32 v152, v152, v153, v154
    s_waitcnt vmcnt(15)
    v_accvgpr_read_b32 v153, a48
    s_waitcnt vmcnt(14)
    v_accvgpr_read_b32 v154, a52
    v_max3_u32 v152, v152, v153, v154
    s_waitcnt vmcnt(13)
    v_accvgpr_read_b32 v153, a56
    s_waitcnt vmcnt(12)
    v_accvgpr_read_b32 v154, a60
    v_max3_u32 v152, v152, v153, v154
    s_waitcnt vmcnt(11)
    v_accvgpr_read_b32 v153, a64
    s_waitcnt vmcnt(10)
    v_accvgpr_read_b32 v154, a68
    v_max3_u32 v152, v152, v153, v154
    s_waitcnt vmcnt(9)
    v_accvgpr_read_b32 v153, a72
    s_waitcnt vmcnt(8)
    v_accvgpr_read_b32 v154, a76
    v_max3_u32 v152, v152, v153, v154
    s_waitcnt vmcnt(7)
    v_accvgpr_read_b32 v153, a80
    s_waitcnt vmcnt(6)
    v_accvgpr_read_b32 v154, a84
    v_max3_u32 v152, v152, v153, v154
    s_waitcnt vmcnt(5)
    v_accvgpr_read_b32 v153, a88
    s_waitcnt vmcnt(4)
    v_accvgpr_read_b32 v154, a92
    v_max3_u32 v152, v152, v153, v154
    s_waitcnt vmcnt(3)
    v_accvgpr_read_b32 v153, a96
    s_waitcnt vmcnt(2)
    v_accvgpr_read_b32 v154, a100
    v_max3_u32 v152, v152, v153, v154
    s_waitcnt vmcnt(1)
    v_accvgpr_read_b32 v153, a104
    s_waitcnt vmcnt(0)
    v_accvgpr_read_b32 v154, a108
    v_max3_u32 v152, v152, v153, v154
    v_cmp_eq_u32 vcc, -1, v152
    s_sub_u32 s66, s66, 1
    s_cbranch_scc1 L_redo2
    s_cmp_lg_u64 vcc, 0
    s_cbranch_scc1 L_redo1
L_redo2:
    v_mfma_f32_32x32x16_bf16 v[80:95], v[160:163], a[0:3], 0
    v_mfma_f32_32x32x16_bf16 v[48:63], v[164:167], a[0:3], 0
    v_mfma_f32_32x32x16_bf16 v[80:95], v[168:171], a[4:7], v[80:95]
    v_mfma_f32_32x32x16_bf16 v[48:63], v[172:175], a[4:7], v[48:63]
    v_mfma_f32_32x32x16_bf16 v[80:95], v[176:179], a[8:11], v[80:95]
    v_mfma_f32_32x32x16_bf16 v[48:63], v[180:183], a[8:11], v[48:63]
    v_mfma_f32_32x32x16_bf16 v[80:95], v[184:187], a[12:15], v[80:95]
    v_mfma_f32_32x32x16_bf16 v[48:63], v[188:191], a[12:15], v[48:63]
    v_mfma_f32_32x32x16_bf16 v[80:95], v[192:195], a[16:19], v[80:95]
    v_mfma_f32_32x32x16_bf16 v[48:63], v[196:199], a[16:19], v[48:63]
    v_mfma_f32_32x32x16_bf16 v[80:95], v[200:203], a[20:23], v[80:95]
    v_mfma_f32_32x32x16_bf16 v[48:63], v[204:207], a[20:23], v[48:63]
    v_mfma_f32_32x32x16_bf16 v[80:95], v[208:211], a[24:27], v[80:95]
    v_mfma_f32_32x32x16_bf16 v[48:63], v[212:215], a[24:27], v[48:63]
    v_mfma_f32_32x32x16_bf16 v[80:95], v[216:219], a[28:31], v[80:95]
    v_mfma_f32_32x32x16_bf16 v[48:63], v[220:223], a[28:31], v[48:63]
    v_mfma_f32_32x32x16_bf16 v[80:95], v[224:227], a[32:35], v[80:95]
    v_mfma_f32_32x32x16_bf16 v[48:63], v[228:231], a[32:35], v[48:63]
    v_mfma_f32_32x32x16_bf16 v[80:95], v[232:235], a[36:39], v[80:95]
    v_mfma_f32_32x32x16_bf16 v[48:63], v[236:239], a[36:39], v[48:63]
    v_mfma_f32_32x32x16_bf16 v[80:95], v[240:243], a[40:43], v[80:95]
    v_mfma_f32_32x32x16_bf16 v[48:63], v[244:247], a[40:43], v[48:63]
    v_mfma_f32_32x32x16_bf16 v[80:95], v[248:251], a[44:47], v[80:95]
    v_mfma_f32_32x32x16_bf16 v[48:63], v[252:255], a[44:47], v[48:63]
    v_mfma_f32_32x32x16_bf16 v[80:95], a[224:227], a[48:51], v[80:95]
    v_mfma_f32_32x32x16_bf16 v[48:63], a[228:231], a[48:51], v[48:63]
    v_mfma_f32_32x32x16_bf16 v[80:95], a[232:235], a[52:55], v[80:95]
    v_mfma_f32_32x32x16_bf16 v[48:63], a[236:239], a[52:55], v[48:63]
    v_mfma_f32_32x32x16_bf16 v[80:95], a[240:243], a[56:59], v[80:95]
    v_mfma_f32_32x32x16_bf16 v[48:63], a[244:247], a[56:59], v[48:63]
    v_mfma_f32_32x32x16_bf16 v[80:95], a[248:251], a[60:63], v[80:95]
    v_mfma_f32_32x32x16_bf16 v[48:63], a[252:255], a[60:63], v[48:63]
    v_mfma_f32_32x32x16_bf16 v[80:95], a[112:115], a[64:67], v[80:95]
    v_mfma_f32_32x32x16_bf16 v[48:63], a[116:119], a[64:67], v[48:63]
    v_mfma_f32_32x32x16_bf16 v[80:95], a[120:123], a[68:71], v[80:95]
    v_mfma_f32_32x32x16_bf16 v[48:63], a[124:127], a[68:71], v[48:63]
    v_mfma_f32_32x32x16_bf16 v[80:95], a[128:131], a[72:75], v[80:95]
    v_mfma_f32_32x32x16_bf16 v[48:63], a[132:135], a[72:75], v[48:63]
    v_mfma_f32_32x32x16_bf16 v[80:95], a[136:139], a[76:79], v[80:95]
    v_mfma_f32_32x32x16_bf16 v[48:63], a[140:143], a[76:79], v[48:63]
    v_mfma_f32_32x32x16_bf16 v[80:95], a[144:147], a[80:83], v[80:95]
    v_mfma_f32_32x32x16_bf16 v[48:63], a[148:151], a[80:83], v[48:63]
    v_mfma_f32_32x32x16_bf16 v[80:95], a[152:155], a[84:87], v[80:95]
    v_mfma_f32_32x32x16_bf16 v[48:63], a[156:159], a[84:87], v[48:63]
    v_mfma_f32_32x32x16_bf16 v[80:95], a[160:163], a[88:91], v[80:95]
    v_mfma_f32_32x32x16_bf16 v[48:63], a[164:167], a[88:91], v[48:63]
    v_mfma_f32_32x32x16_bf16 v[80:95], a[168:171], a[92:95], v[80:95]
    v_mfma_f32_32x32x16_bf16 v[48:63], a[172:175], a[92:95], v[48:63]
    v_mfma_f32_32x32x16_bf16 v[80:95], a[176:179], a[96:99], v[80:95]
    v_mfma_f32_32x32x16_bf16 v[48:63], a[180:183], a[96:99], v[48:63]
    v_mfma_f32_32x32x16_bf16 v[80:95], a[184:187], a[100:103], v[80:95]
    v_mfma_f32_32x32x16_bf16 v[48:63], a[188:191], a[100:103], v[48:63]
    v_mfma_f32_32x32x16_bf16 v[80:95], a[192:195], a[104:107], v[80:95]
    v_mfma_f32_32x32x16_bf16 v[48:63], a[196:199], a[104:107], v[48:63]
    v_mfma_f32_32x32x16_bf16 v[80:95], a[200:203], a[108:111], v[80:95]
    v_mfma_f32_32x32x16_bf16 v[48:63], a[204:207], a[108:111], v[48:63]
    v_lshlrev_b32 v144, 16, v136
    v_and_b32 v145, s4, v136
    v_lshlrev_b32 v146, 16, v137
    v_and_b32 v147, s4, v137
    v_lshlrev_b32 v148, 16, v138
    v_and_b32 v149, s4, v138
    v_lshlrev_b32 v150, 16, v139
    v_and_b32 v151, s4, v139
    s_nop 2
    ds_write_b128 v119, v[80:83] offset:0
    ds_write_b128 v119, v[84:87] offset:1152
    ds_write_b128 v119, v[88:91] offset:2432
    ds_write_b128 v119, v[92:95] offset:3584
    ds_write_b128 v119, v[48:51] offset:4864
    ds_write_b128 v119, v[52:55] offset:6016
    ds_write_b128 v119, v[56:59] offset:7296
    ds_write_b128 v119, v[60:63] offset:8448
    s_branch L_redone
L_red:
    v_mfma_f32_32x32x16_bf16 v[144:159], a[40:43], v[108:111], v[144:159]
    ds_read_b64_tr_b16 v[96:97], v218 offset:50176
    ds_read_b64_tr_b16 v[98:99], v218 offset:50688
    s_mov_b32 exec_hi, 0xff
    buffer_store_dwordx4 v[220:223], v2, s[16:19], s7 offen sc1
    s_mov_b32 exec_hi, -1
    s_and_b32 s56, s2, 31
    s_lshl_b32 s56, s56, 10
    s_lshl4_add_u32 s56, s6, s56
    s_add_u32 s56, s56, 1441792
    s_add_u32 s57, s56, 0x8000
    buffer_store_dwordx4 v[220:223], v2, s[16:19], s56 offen sc1
    buffer_store_dwordx4 v[220:223], v2, s[16:19], s57 offen sc1
    s_waitcnt lgkmcnt(5)
    v_mfma_f32_32x32x16_bf16 v[128:143], a[44:47], v[116:119], v[128:143]
    ds_read_b128 a[52:55], v13 offset:24576
    ds_read_b64_tr_b16 v[104:105], v16 offset:53248
    ds_read_b64_tr_b16 v[106:107], v16 offset:53760
    s_movk_i32 s67, 768
    v_lshrrev_b32 v253, 3, v1
    v_mfma_f32_32x32x16_bf16 v[144:159], a[44:47], v[120:123], v[144:159]
    ds_read_b64_tr_b16 v[108:109], v218 offset:54272
    ds_read_b64_tr_b16 v[110:111], v218 offset:54784
    v_lshl_add_u32 v253, s48, 4, v253
    v_mul_u32_u24 v253, 1792, v253
    s_waitcnt lgkmcnt(5)
    v_mfma_f32_32x32x16_bf16 v[128:143], a[48:51], v[92:95], v[128:143]
    ds_read_b128 a[56:59], v14 offset:24576
    ds_read_b64_tr_b16 v[116:117], v16 offset:57344
    ds_read_b64_tr_b16 v[118:119], v16 offset:57856
    v_sub_u32 v216, v216, v253
    v_mfma_f32_32x32x16_bf16 v[144:159], a[48:51], v[96:99], v[144:159]
    ds_read_b64_tr_b16 v[120:121], v218 offset:58368
    ds_read_b64_tr_b16 v[122:123], v218 offset:58880
    v_add_u32 v217, 5120, v216
    s_lshr_b32 s61, s48, 1
    s_xor_b32 s61, s61, s48
    s_waitcnt lgkmcnt(5)
    v_mfma_f32_32x32x16_bf16 v[128:143], a[52:55], v[104:107], v[128:143]
    ds_read_b128 a[60:63], v15 offset:24576
    ds_read_b64_tr_b16 v[92:93], v16 offset:61440
    ds_read_b64_tr_b16 v[94:95], v16 offset:61952
    s_and_b32 s61, s61, 1
    s_lshl_b32 s61, s61, 6
    v_mfma_f32_32x32x16_bf16 v[144:159], a[52:55], v[108:111], v[144:159]
    ds_read_b64_tr_b16 v[96:97], v218 offset:62464
    ds_read_b64_tr_b16 v[98:99], v218 offset:62976
    v_xor_b32 v244, s61, v18
    v_xor_b32 v245, s61, v19
    s_waitcnt lgkmcnt(5)
    v_mfma_f32_32x32x16_bf16 v[128:143], a[56:59], v[116:119], v[128:143]
    s_waitcnt vmcnt(11)
    s_barrier
    ds_read_b128 a[64:67], v12 offset:32768
    ds_read_b64_tr_b16 v[104:105], v17 offset:0
    ds_read_b64_tr_b16 v[106:107], v17 offset:512
    v_mfma_f32_32x32x16_bf16 v[144:159], a[56:59], v[120:123], v[144:159]
    ds_read_b64_tr_b16 v[108:109], v219 offset:1024
    ds_read_b64_tr_b16 v[110:111], v219 offset:1536
    buffer_load_dword v214, off, s[40:43], 0 sc1
    s_waitcnt lgkmcnt(5)
    v_mfma_f32_32x32x16_bf16 v[128:143], a[60:63], v[92:95], v[128:143]
    ds_read_b128 a[68:71], v13 offset:32768
    ds_read_b64_tr_b16 v[116:117], v17 offset:4096
    ds_read_b64_tr_b16 v[118:119], v17 offset:4608
    s_and_b32 s61, s2, 31
    v_mfma_f32_32x32x16_bf16 v[144:159], a[60:63], v[96:99], v[144:159]
    ds_read_b64_tr_b16 v[120:121], v219 offset:5120
    ds_read_b64_tr_b16 v[122:123], v219 offset:5632
    s_add_u32 m0, s6, 81920
    s_nop 0
    buffer_load_dwordx4 v216, s[20:23], s67 offen offset:0 lds
    s_waitcnt lgkmcnt(5)
    v_mfma_f32_32x32x16_bf16 v[128:143], a[64:67], v[104:107], v[128:143]
    ds_read_b128 a[72:75], v14 offset:32768
    ds_read_b64_tr_b16 v[92:93], v17 offset:8192
    ds_read_b64_tr_b16 v[94:95], v17 offset:8704
    buffer_load_dwordx4 v217, s[20:23], s67 offen offset:2048 lds
    s_add_u32 s67, s67, 57344
    v_mfma_f32_32x32x16_bf16 v[144:159], a[64:67], v[108:111], v[144:159]
    ds_read_b64_tr_b16 v[96:97], v219 offset:9216
    ds_read_b64_tr_b16 v[98:99], v219 offset:9728
    s_lshl_b32 s80, s61, 15
    s_lshl_b32 s64, s48, 8
    s_waitcnt lgkmcnt(5)
    v_mfma_f32_32x32x16_bf16 v[128:143], a[68:71], v[116:119], v[128:143]
    ds_read_b128 a[76:79], v15 offset:32768
    ds_read_b64_tr_b16 v[104:105], v17 offset:12288
    ds_read_b64_tr_b16 v[106:107], v17 offset:12800
    s_add_u32 m0, s6, 82944
    s_nop 0
    buffer_load_dwordx4 v216, s[20:23], s67 offen offset:0 lds
    v_mfma_f32_32x32x16_bf16 v[144:159], a[68:71], v[120:123], v[144:159]
    ds_read_b64_tr_b16 v[108:109], v219 offset:13312
    ds_read_b64_tr_b16 v[110:111], v219 offset:13824
    buffer_load_dwordx4 v217, s[20:23], s67 offen offset:2048 lds
    s_add_u32 s67, s67, 57344
    s_waitcnt lgkmcnt(5)
    v_mfma_f32_32x32x16_bf16 v[128:143], a[72:75], v[92:95], v[128:143]
    s_waitcnt vmcnt(12)
    s_barrier
    ds_read_b128 a[80:83], v12 offset:40960
    ds_read_b64_tr_b16 v[116:117], v17 offset:16384
    ds_read_b64_tr_b16 v[118:119], v17 offset:16896
    v_mfma_f32_32x32x16_bf16 v[144:159], a[72:75], v[96:99], v[144:159]
    ds_read_b64_tr_b16 v[120:121], v219 offset:17408
    ds_read_b64_tr_b16 v[122:123], v219 offset:17920
    s_add_u32 s80, s80, s64
    s_lshl_b32 s56, s61, 10
    s_waitcnt lgkmcnt(5)
    v_mfma_f32_32x32x16_bf16 v[128:143], a[76:79], v[104:107], v[128:143]
    ds_read_b128 a[84:87], v13 offset:40960
    ds_read_b64_tr_b16 v[92:93], v17 offset:20480
    ds_read_b64_tr_b16 v[94:95], v17 offset:20992
    v_mfma_f32_32x32x16_bf16 v[144:159], a[76:79], v[108:111], v[144:159]
    ds_read_b64_tr_b16 v[96:97], v219 offset:21504
    ds_read_b64_tr_b16 v[98:99], v219 offset:22016
    s_add_u32 m0, s6, 98304
    s_nop 0
    buffer_load_dwordx4 v216, s[20:23], s67 offen offset:0 lds
    s_waitcnt lgkmcnt(5)
    v_mfma_f32_32x32x16_bf16 v[128:143], a[80:83], v[116:119], v[128:143]
    ds_read_b128 a[88:91], v14 offset:40960
    ds_read_b64_tr_b16 v[104:105], v17 offset:24576
    ds_read_b64_tr_b16 v[106:107], v17 offset:25088
    buffer_load_dwordx4 v217, s[20:23], s67 offen offset:2048 lds
    s_add_u32 s67, s67, 57344
    v_mfma_f32_32x32x16_bf16 v[144:159], a[80:83], v[120:123], v[144:159]
    ds_read_b64_tr_b16 v[108:109], v219 offset:25600
    ds_read_b64_tr_b16 v[110:111], v219 offset:26112
    s_add_u32 s56, s56, s64
    s_add_u32 s56, s56, 1441792
    s_waitcnt lgkmcnt(5)
    v_mfma_f32_32x32x16_bf16 v[128:143], a[84:87], v[92:95], v[128:143]
    ds_read_b128 a[92:95], v15 offset:40960
    ds_read_b64_tr_b16 v[116:117], v17 offset:28672
    ds_read_b64_tr_b16 v[118:119], v17 offset:29184
    s_add_u32 m0, s6, 99328
    s_nop 0
    buffer_load_dwordx4 v216, s[20:23], s67 offen offset:0 lds
    v_mfma_f32_32x32x16_bf16 v[144:159], a[84:87], v[96:99], v[144:159]
    ds_read_b64_tr_b16 v[120:121], v219 offset:29696
    ds_read_b64_tr_b16 v[122:123], v219 offset:30208
    buffer_load_dwordx4 v217, s[20:23], s67 offen offset:2048 lds
    s_add_u32 s67, s67, 57344
    s_waitcnt lgkmcnt(5)
    v_mfma_f32_32x32x16_bf16 v[128:143], a[88:91], v[104:107], v[128:143]
    s_waitcnt vmcnt(12)
    s_barrier
    ds_read_b128 a[96:99], v12 offset:49152
    ds_read_b64_tr_b16 v[92:93], v16 offset:0
    ds_read_b64_tr_b16 v[94:95], v16 offset:512
    v_mfma_f32_32x32x16_bf16 v[144:159], a[88:91], v[108:111], v[144:159]
    ds_read_b64_tr_b16 v[96:97], v218 offset:1024
    ds_read_b64_tr_b16 v[98:99], v218 offset:1536
    s_add_u32 m0, s6, 114688
    s_nop 0
    buffer_load_dwordx4 v216, s[20:23], s67 offen offset:0 lds
    s_add_u32 s57, s56, 0x20000
    s_lshl_b32 s78, s61, 12
    s_waitcnt lgkmcnt(5)
    v_mfma_f32_32x32x16_bf16 v[128:143], a[92:95], v[116:119], v[128:143]
    ds_read_b128 a[100:103], v13 offset:49152
    ds_read_b64_tr_b16 v[104:105], v16 offset:4096
    ds_read_b64_tr_b16 v[106:107], v16 offset:4608
    buffer_load_dwordx4 v217, s[20:23], s67 offen offset:2048 lds
    s_add_u32 s67, s67, 57344
    s_add_u32 s78, s78, 1179648
    v_mfma_f32_32x32x16_bf16 v[144:159], a[92:95], v[120:123], v[144:159]
    ds_read_b64_tr_b16 v[108:109], v218 offset:5120
    ds_read_b64_tr_b16 v[110:111], v218 offset:5632
    s_lshl_b32 s69, s61, 7
    s_add_u32 s69, s69, 1310720
    s_waitcnt lgkmcnt(5)
    v_mfma_f32_32x32x16_bf16 v[128:143], a[96:99], v[92:95], v[128:143]
    ds_read_b128 a[104:107], v14 offset:49152
    ds_read_b64_tr_b16 v[116:117], v16 offset:8192
    ds_read_b64_tr_b16 v[118:119], v16 offset:8704
    s_add_u32 m0, s6, 115712
    s_nop 0
    buffer_load_dwordx4 v216, s[20:23], s67 offen offset:0 lds
    v_and_b32 v4, 15, v1
    v_mfma_f32_32x32x16_bf16 v[144:159], a[96:99], v[96:99], v[144:159]
    ds_read_b64_tr_b16 v[120:121], v218 offset:9216
    ds_read_b64_tr_b16 v[122:123], v218 offset:9728
    v_lshlrev_b32 v4, 4, v4
    s_waitcnt lgkmcnt(5)
    v_mfma_f32_32x32x16_bf16 v[128:143], a[100:103], v[104:107], v[128:143]
    ds_read_b128 a[108:111], v15 offset:49152
    ds_read_b64_tr_b16 v[92:93], v16 offset:12288
    ds_read_b64_tr_b16 v[94:95], v16 offset:12800
    buffer_load_dwordx4 v217, s[20:23], s67 offen offset:2048 lds
    s_add_u32 s67, s67, 57344
    v_lshrrev_b32 v6, 4, v1
    v_mfma_f32_32x32x16_bf16 v[144:159], a[100:103], v[108:111], v[144:159]
    ds_read_b64_tr_b16 v[96:97], v218 offset:13312
    ds_read_b64_tr_b16 v[98:99], v218 offset:13824
    v_lshl_add_u32 v80, v6, 10, v4
    s_waitcnt lgkmcnt(5)
    v_mfma_f32_32x32x16_bf16 v[128:143], a[104:107], v[116:119], v[128:143]
    s_add_u32 m0, s6, 131072
    s_nop 0
    buffer_load_dwordx4 v216, s[20:23], s67 offen offset:0 lds
    v_lshl_add_u32 v81, v6, 15, v4
    v_lshlrev_b32 v82, 7, v1
    v_lshl_add_u32 v83, v1, 12, v224
    s_movk_i32 s46, 0x3f80
    s_mov_b32 s47, 0x3f800000
    v_mfma_f32_32x32x16_bf16 v[144:159], a[104:107], v[120:123], v[144:159]
    s_and_b32 s61, s61, 3
    s_lshr_b32 s64, s48, 1
    s_lshl2_add_u32 s61, s64, s61
    s_or_b32 s61, s61, 0x10000
    s_bfe_i32 s76, 0xfb, s61
    s_bfe_i32 s77, 0xdf, s61
    s_waitcnt lgkmcnt(0)
    v_mfma_f32_32x32x16_bf16 v[128:143], a[108:111], v[92:95], v[128:143]
    buffer_load_dwordx4 v217, s[20:23], s67 offen offset:2048 lds
    s_add_u32 s67, s67, 57344
    v_mfma_f32_32x32x16_bf16 v[144:159], a[108:111], v[96:99], v[144:159]
    s_waitcnt vmcnt(14)
    v_cmp_gt_u32 vcc, 32, v214
    s_nop 0
    s_cmp_lg_u32 vcc_lo, 0
    s_cbranch_scc1 L_init_nor
L_init_okr:
    s_nop 3
    v_pk_fma_f32 v[128:129], v[128:129], s[70:71], v[200:201]
    v_pk_fma_f32 v[130:131], v[130:131], s[70:71], v[200:201]
    v_pk_fma_f32 v[132:133], v[132:133], s[70:71], v[200:201]
    v_pk_fma_f32 v[134:135], v[134:135], s[70:71], v[200:201]
    v_exp_f32 v202, v128 clamp
    v_exp_f32 v203, v129 clamp
    v_max_f32 v128, v200, v128
    v_max_f32 v129, v200, v129
    v_pk_fma_f32 v[128:129], v[128:129], s[72:73], v[202:203]
    v_exp_f32 v204, v130 clamp
    v_exp_f32 v205, v131 clamp
    v_max_f32 v130, v200, v130
    v_max_f32 v131, v200, v131
    v_pk_fma_f32 v[130:131], v[130:131], s[72:73], v[204:205]
    v_exp_f32 v206, v132 clamp
    v_exp_f32 v207, v133 clamp
    v_max_f32 v132, v200, v132
    v_max_f32 v133, v200, v133
    v_pk_fma_f32 v[132:133], v[132:133], s[72:73], v[206:207]
    v_exp_f32 v208, v134 clamp
    v_exp_f32 v209, v135 clamp
    v_max_f32 v134, v200, v134
    v_max_f32 v135, v200, v135
    v_pk_fma_f32 v[134:135], v[134:135], s[72:73], v[208:209]
    v_cvt_pk_bf16_f32 v56, v144, v145
    v_cvt_pk_bf16_f32 v48, v128, v129
    v_cndmask_b32 v56, v56, v28, s[44:45]
    v_cvt_pk_bf16_f32 v57, v146, v147
    v_cvt_pk_bf16_f32 v49, v130, v131
    v_cndmask_b32 v57, v57, v28, s[44:45]
    v_cvt_pk_bf16_f32 v58, v148, v149
    v_cvt_pk_bf16_f32 v50, v132, v133
    v_cndmask_b32 v58, v58, v28, s[44:45]
    v_cvt_pk_bf16_f32 v59, v150, v151
    v_cvt_pk_bf16_f32 v51, v134, v135
    v_cndmask_b32 v59, v59, v28, s[44:45]
    s_nop 1
    v_mfma_f32_32x32x16_bf16 v[176:191], v[48:51], v[56:59], 0
    s_mov_b64 exec, 1
    buffer_store_dword v28, off, s[16:19], s59 sc1
    s_mov_b64 exec, -1
    v_pk_fma_f32 v[136:137], v[136:137], s[70:71], v[200:201]
    v_pk_fma_f32 v[138:139], v[138:139], s[70:71], v[200:201]
    v_pk_fma_f32 v[140:141], v[140:141], s[70:71], v[200:201]
    v_pk_fma_f32 v[142:143], v[142:143], s[70:71], v[200:201]
    v_exp_f32 v202, v136 clamp
    v_exp_f32 v203, v137 clamp
    v_max_f32 v136, v200, v136
    v_max_f32 v137, v200, v137
    v_pk_fma_f32 v[136:137], v[136:137], s[72:73], v[202:203]
    v_exp_f32 v204, v138 clamp
    v_exp_f32 v205, v139 clamp
    v_max_f32 v138, v200, v138
    v_max_f32 v139, v200, v139
    v_pk_fma_f32 v[138:139], v[138:139], s[72:73], v[204:205]
    v_exp_f32 v206, v140 clamp
    v_exp_f32 v207, v141 clamp
    v_max_f32 v140, v200, v140
    v_max_f32 v141, v200, v141
    v_pk_fma_f32 v[140:141], v[140:141], s[72:73], v[206:207]
    v_exp_f32 v208, v142 clamp
    v_exp_f32 v209, v143 clamp
    v_max_f32 v142, v200, v142
    v_max_f32 v143, v200, v143
    v_pk_fma_f32 v[142:143], v[142:143], s[72:73], v[208:209]
    v_cvt_pk_bf16_f32 v60, v152, v153
    v_cvt_pk_bf16_f32 v52, v136, v137
    v_cndmask_b32 v60, v60, v28, s[44:45]
    v_cvt_pk_bf16_f32 v61, v154, v155
    v_cvt_pk_bf16_f32 v53, v138, v139
    v_cndmask_b32 v61, v61, v28, s[44:45]
    v_cvt_pk_bf16_f32 v62, v156, v157
    v_cvt_pk_bf16_f32 v54, v140, v141
    v_cndmask_b32 v62, v62, v28, s[44:45]
    v_cvt_pk_bf16_f32 v63, v158, v159
    v_cvt_pk_bf16_f32 v55, v142, v143
    v_cndmask_b32 v63, v63, v28, s[44:45]
    s_nop 1
    v_mfma_f32_32x32x16_bf16 v[176:191], v[52:55], v[60:63], v[176:191]
    s_nop 11
    ds_write_b128 v225, v[184:187] offset:0
    ds_write_b128 v225, v[188:191] offset:1024
    s_waitcnt lgkmcnt(0)
    s_barrier
    ds_read_b128 v[88:91], v215 offset:0
    ds_read_b128 v[92:95], v215 offset:1024
    s_waitcnt lgkmcnt(1)
    v_add_f32 v88, v88, v176
    v_add_f32 v89, v89, v177
    v_cvt_pk_bf16_f32 v96, v88, v89
    v_add_f32 v90, v90, v178
    v_add_f32 v91, v91, v179
    v_cvt_pk_bf16_f32 v97, v90, v91
    s_waitcnt lgkmcnt(0)
    v_add_f32 v92, v92, v180
    v_add_f32 v93, v93, v181
    v_cvt_pk_bf16_f32 v98, v92, v93
    v_add_f32 v94, v94, v182
    v_add_f32 v95, v95, v183
    v_cvt_pk_bf16_f32 v99, v94, v95
    buffer_store_dwordx4 v[96:99], v2, s[16:19], s79 offen sc1
    s_mov_b32 exec_lo, 0xffffffff
    s_mov_b32 exec_hi, 0x0
    s_movk_i32 s66, 0x4000
L_fp_11:
    buffer_load_dword v7, v82, s[16:19], s78 offen sc1
    s_waitcnt vmcnt(0)
    v_cmp_eq_u32 vcc, -1, v7
    s_sub_u32 s66, s66, 1
    s_cbranch_scc1 L_fpd_12
    s_and_b64 exec, vcc, exec
    s_cbranch_scc1 L_fp_11
L_fpd_12:
    s_mov_b64 exec, -1
    s_mov_b32 s62, s80
    buffer_load_dwordx4 v[32:35], v80, s[16:19], s62 offen sc1
    s_addk_i32 s62, 4096
    buffer_load_dwordx4 v[36:39], v80, s[16:19], s62 offen sc1
    s_addk_i32 s62, 4096
    buffer_load_dwordx4 v[40:43], v80, s[16:19], s62 offen sc1
    s_addk_i32 s62, 4096
    buffer_load_dwordx4 v[44:47], v80, s[16:19], s62 offen sc1
    s_addk_i32 s62, 4096
    buffer_load_dwordx4 v[48:51], v80, s[16:19], s62 offen sc1
    s_addk_i32 s62, 4096
    buffer_load_dwordx4 v[52:55], v80, s[16:19], s62 offen sc1
    s_addk_i32 s62, 4096
    buffer_load_dwordx4 v[56:59], v80, s[16:19], s62 offen sc1
    s_addk_i32 s62, 4096
    buffer_load_dwordx4 v[60:63], v80, s[16:19], s62 offen sc1
    v_mov_b32 v64, 0
    v_mov_b32 v65, 0
    v_mov_b32 v66, 0
    v_mov_b32 v67, 0
    v_mov_b32 v68, 0
    v_mov_b32 v69, 0
    v_mov_b32 v70, 0
    v_mov_b32 v71, 0
    s_waitcnt vmcnt(7)
    v_dot2c_f32_bf16 v64, s46, v32
    v_dot2c_f32_bf16 v65, s47, v32
    v_dot2c_f32_bf16 v66, s46, v33
    v_dot2c_f32_bf16 v67, s47, v33
    v_dot2c_f32_bf16 v68, s46, v34
    v_dot2c_f32_bf16 v69, s47, v34
    v_dot2c_f32_bf16 v70, s46, v35
    v_dot2c_f32_bf16 v71, s47, v35
    s_mov_b64 exec, 0xff
    buffer_store_dword v28, v83, s[16:19], s69 offen sc1
    s_mov_b64 exec, -1
    s_waitcnt vmcnt(7)
    v_dot2c_f32_bf16 v64, s46, v36
    v_dot2c_f32_bf16 v65, s47, v36
    v_dot2c_f32_bf16 v66, s46, v37
    v_dot2c_f32_bf16 v67, s47, v37
    v_dot2c_f32_bf16 v68, s46, v38
    v_dot2c_f32_bf16 v69, s47, v38
    v_dot2c_f32_bf16 v70, s46, v39
    v_dot2c_f32_bf16 v71, s47, v39
    v_max3_u32 v7, v32, v32, v36
    s_waitcnt vmcnt(6)
    v_dot2c_f32_bf16 v64, s46, v40
    v_dot2c_f32_bf16 v65, s47, v40
    v_dot2c_f32_bf16 v66, s46, v41
    v_dot2c_f32_bf16 v67, s47, v41
    v_dot2c_f32_bf16 v68, s46, v42
    v_dot2c_f32_bf16 v69, s47, v42
    v_dot2c_f32_bf16 v70, s46, v43
    v_dot2c_f32_bf16 v71, s47, v43
    s_waitcnt vmcnt(5)
    v_dot2c_f32_bf16 v64, s46, v44
    v_dot2c_f32_bf16 v65, s47, v44
    v_dot2c_f32_bf16 v66, s46, v45
    v_dot2c_f32_bf16 v67, s47, v45
    v_dot2c_f32_bf16 v68, s46, v46
    v_dot2c_f32_bf16 v69, s47, v46
    v_dot2c_f32_bf16 v70, s46, v47
    v_dot2c_f32_bf16 v71, s47, v47
    v_max3_u32 v7, v7, v40, v44
    s_waitcnt vmcnt(4)
    v_dot2c_f32_bf16 v64, s46, v48
    v_dot2c_f32_bf16 v65, s47, v48
    v_dot2c_f32_bf16 v66, s46, v49
    v_dot2c_f32_bf16 v67, s47, v49
    v_dot2c_f32_bf16 v68, s46, v50
    v_dot2c_f32_bf16 v69, s47, v50
    v_dot2c_f32_bf16 v70, s46, v51
    v_dot2c_f32_bf16 v71, s47, v51
    s_waitcnt vmcnt(3)
    v_dot2c_f32_bf16 v64, s46, v52
    v_dot2c_f32_bf16 v65, s47, v52
    v_dot2c_f32_bf16 v66, s46, v53
    v_dot2c_f32_bf16 v67, s47, v53
    v_dot2c_f32_bf16 v68, s46, v54
    v_dot2c_f32_bf16 v69, s47, v54
    v_dot2c_f32_bf16 v70, s46, v55
    v_dot2c_f32_bf16 v71, s47, v55
    v_max3_u32 v7, v7, v48, v52
    s_waitcnt vmcnt(2)
    v_dot2c_f32_bf16 v64, s46, v56
    v_dot2c_f32_bf16 v65, s47, v56
    v_dot2c_f32_bf16 v66, s46, v57
    v_dot2c_f32_bf16 v67, s47, v57
    v_dot2c_f32_bf16 v68, s46, v58
    v_dot2c_f32_bf16 v69, s47, v58
    v_dot2c_f32_bf16 v70, s46, v59
    v_dot2c_f32_bf16 v71, s47, v59
    s_waitcnt vmcnt(1)
    v_dot2c_f32_bf16 v64, s46, v60
    v_dot2c_f32_bf16 v65, s47, v60
    v_dot2c_f32_bf16 v66, s46, v61
    v_dot2c_f32_bf16 v67, s47, v61
    v_dot2c_f32_bf16 v68, s46, v62
    v_dot2c_f32_bf16 v69, s47, v62
    v_dot2c_f32_bf16 v70, s46, v63
    v_dot2c_f32_bf16 v71, s47, v63
    v_max3_u32 v7, v7, v56, v60
    v_cmp_eq_u32 vcc, -1, v7
    s_nop 0
    s_cmp_lg_u64 vcc, 0
    s_cbranch_scc1 L_r_again
L_r_go:
    v_permlane32_swap_b32 v64, v68
    v_permlane32_swap_b32 v65, v69
    v_permlane32_swap_b32 v66, v70
    v_permlane32_swap_b32 v67, v71
    v_add_f32 v64, v64, v68
    v_add_f32 v65, v65, v69
    v_add_f32 v66, v66, v70
    v_add_f32 v67, v67, v71
    s_nop 0
    v_permlane16_swap_b32 v64, v66
    v_permlane16_swap_b32 v65, v67
    v_add_f32 v64, v64, v66
    v_add_f32 v65, v65, v67
    v_cvt_pk_bf16_f32 v64, v64, v65
    v_cndmask_b32 v64, 0, v64, s[76:77]
    v_mov_b32 v65, v64
    s_nop 1
    v_permlane16_swap_b32 v64, v65
    v_mov_b32 v66, v64
    v_mov_b32 v67, v65
    s_nop 0
    v_permlane32_swap_b32 v64, v66
    v_permlane32_swap_b32 v65, v67
    buffer_store_dwordx4 v[64:67], v81, s[16:19], s56 offen sc1
    buffer_store_dwordx4 v[64:67], v81, s[16:19], s57 offen sc1
    s_barrier
    s_mul_i32 s64, s48, 7
    s_lshr_b32 s64, s64, 1
    s_lshl4_add_u32 s71, s74, s64
    s_lshl_b32 s71, s71, 7
    s_lshl2_add_u32 s64, s49, s48
    s_lshl_b32 s64, s64, 10
    s_add_u32 s64, s64, 261632
    s_sub_u32 s64, s64, s71
    s_add_u32 s71, s71, 1048576
    v_lshlrev_b32 v40, 7, v1
    v_add_u32 v4, s64, v40
    v_cmp_gt_u32 vcc, 4, v1
    s_nop 1
    v_cndmask_b32 v40, v4, v40, vcc
    s_mul_i32 s61, s74, 28672
    s_mul_i32 s63, s48, 7168
    s_add_u32 s70, s61, s63
    s_add_u32 s70, s70, 2097152
    v_and_b32 v4, 31, v1
    v_lshrrev_b32 v5, 5, v1
    v_mul_u32_u24 v6, 896, v4
    v_lshl_add_u32 v6, v5, 4, v6
    s_lshl2_add_u32 s59, s75, s48
    s_min_u32 s64, s59, 13
    s_lshl_b32 s64, s64, 6
    s_add_u32 s61, s61, s64
    buffer_load_dwordx4 v[32:35], v6, s[8:11], s61 offen
    buffer_load_dwordx4 v[36:39], v6, s[8:11], s61 offen offset:32
    v_lshlrev_b32 v4, 4, v4
    v_add_u32 v4, s63, v4
    v_lshl_add_u32 v24, v5, 3, v4
    v_mul_u32_u24 v5, 504, v5
    v_add3_u32 v25, v5, v4, 8
    s_lshl_b32 s72, s49, 15
    s_lshl1_add_u32 s72, s6, s72
    s_add_u32 s72, s72, 1441792
    s_add_u32 s73, s72, 4096
    s_mul_i32 s58, s74, 14
    s_add_u32 s58, s58, s59
    s_add_u32 s64, s59, 2
    s_lshr_b32 s64, s64, 4
    s_mul_i32 s64, s64, 5120
    s_add_u32 s58, s58, s64
    s_lshl_b32 s58, s58, 11
    s_add_u32 s58, s58, 4194304
    s_lshl4_add_u32 s55, s74, s59
    s_lshl_b32 s55, s55, 8
    s_add_u32 s55, s55, 3932160
    s_add_u32 s67, s70, 3584
    ds_read_b64_tr_b16 v[128:129], v244 offset:16384
    ds_read_b64_tr_b16 v[130:131], v244 offset:16896
    ds_read_b64_tr_b16 v[132:133], v244 offset:20480
    ds_read_b64_tr_b16 v[134:135], v244 offset:20992
    ds_read_b64_tr_b16 v[136:137], v244 offset:24576
    ds_read_b64_tr_b16 v[138:139], v244 offset:25088
    ds_read_b64_tr_b16 v[140:141], v244 offset:28672
    ds_read_b64_tr_b16 v[142:143], v244 offset:29184
    ds_read_b64_tr_b16 v[144:145], v244 offset:17408
    ds_read_b64_tr_b16 v[146:147], v244 offset:17920
    ds_read_b64_tr_b16 v[148:149], v244 offset:21504
    ds_read_b64_tr_b16 v[150:151], v244 offset:22016
    ds_read_b64_tr_b16 v[152:153], v244 offset:25600
    ds_read_b64_tr_b16 v[154:155], v244 offset:26112
    ds_read_b64_tr_b16 v[156:157], v244 offset:29696
    ds_read_b64_tr_b16 v[158:159], v244 offset:30208
    ds_read_b64_tr_b16 v[160:161], v244 offset:32768
    ds_read_b64_tr_b16 v[162:163], v244 offset:33280
    ds_read_b64_tr_b16 v[164:165], v244 offset:36864
    ds_read_b64_tr_b16 v[166:167], v244 offset:37376
    ds_read_b64_tr_b16 v[168:169], v244 offset:40960
    ds_read_b64_tr_b16 v[170:171], v244 offset:41472
    ds_read_b64_tr_b16 v[172:173], v244 offset:45056
    ds_read_b64_tr_b16 v[174:175], v244 offset:45568
    ds_read_b64_tr_b16 v[176:177], v244 offset:33792
    ds_read_b64_tr_b16 v[178:179], v244 offset:34304
    ds_read_b64_tr_b16 v[180:181], v244 offset:37888
    ds_read_b64_tr_b16 v[182:183], v244 offset:38400
    ds_read_b64_tr_b16 v[184:185], v244 offset:41984
    ds_read_b64_tr_b16 v[186:187], v244 offset:42496
    ds_read_b64_tr_b16 v[188:189], v244 offset:46080
    ds_read_b64_tr_b16 v[190:191], v244 offset:46592
    ds_read_b64_tr_b16 v[192:193], v244 offset:49152
    ds_read_b64_tr_b16 v[194:195], v244 offset:49664
    ds_read_b64_tr_b16 v[196:197], v244 offset:53248
    ds_read_b64_tr_b16 v[198:199], v244 offset:53760
    ds_read_b64_tr_b16 v[200:201], v244 offset:57344
    ds_read_b64_tr_b16 v[202:203], v244 offset:57856
    ds_read_b64_tr_b16 v[204:205], v244 offset:61440
    ds_read_b64_tr_b16 v[206:207], v244 offset:61952
    ds_read_b64_tr_b16 v[208:209], v244 offset:50176
    ds_read_b64_tr_b16 v[210:211], v244 offset:50688
    ds_read_b64_tr_b16 v[212:213], v244 offset:54272
    ds_read_b64_tr_b16 v[214:215], v244 offset:54784
    ds_read_b64_tr_b16 v[216:217], v244 offset:58368
    ds_read_b64_tr_b16 v[218:219], v244 offset:58880
    ds_read_b64_tr_b16 v[220:221], v244 offset:62464
    ds_read_b64_tr_b16 v[222:223], v244 offset:62976
    ds_read_b64_tr_b16 v[224:225], v245 offset:0
    ds_read_b64_tr_b16 v[226:227], v245 offset:512
    ds_read_b64_tr_b16 v[228:229], v245 offset:4096
    ds_read_b64_tr_b16 v[230:231], v245 offset:4608
    ds_read_b64_tr_b16 v[232:233], v245 offset:8192
    ds_read_b64_tr_b16 v[234:235], v245 offset:8704
    ds_read_b64_tr_b16 v[236:237], v245 offset:12288
    ds_read_b64_tr_b16 v[238:239], v245 offset:12800
    s_mov_b32 exec_lo, 0xfff
    s_mov_b32 exec_hi, 0x0
    s_movk_i32 s66, 0x4000
L_fq_13:
    buffer_load_dword v7, v40, s[16:19], s71 offen sc1
    s_waitcnt vmcnt(0)
    v_cmp_eq_u32 vcc, -1, v7
    s_sub_u32 s66, s66, 1
    s_cbranch_scc1 L_fqd_14
    s_and_b64 exec, vcc, exec
    s_cbranch_scc1 L_fq_13
L_fqd_14:
    s_mov_b64 exec, -1
    buffer_load_dwordx4 a[224:227], v2, s[16:19], s70 offen offset:0 sc1
    buffer_load_dwordx4 a[228:231], v2, s[16:19], s70 offen offset:1024 sc1
    buffer_load_dwordx4 a[232:235], v2, s[16:19], s70 offen offset:1536 sc1
    buffer_load_dwordx4 a[236:239], v2, s[16:19], s70 offen offset:2560 sc1
    buffer_load_dwordx4 a[240:243], v2, s[16:19], s67 offen offset:0 sc1
    buffer_load_dwordx4 a[244:247], v2, s[16:19], s67 offen offset:1024 sc1
    buffer_load_dwordx4 a[248:251], v2, s[16:19], s67 offen offset:1536 sc1
    buffer_load_dwordx4 a[252:255], v2, s[16:19], s67 offen offset:2560 sc1
    buffer_load_dwordx4 v[96:99], v2, s[16:19], s72 offen offset:0 sc1
    buffer_load_dwordx4 v[100:103], v2, s[16:19], s72 offen offset:1024 sc1
    buffer_load_dwordx4 v[104:107], v2, s[16:19], s72 offen offset:2048 sc1
    buffer_load_dwordx4 v[108:111], v2, s[16:19], s72 offen offset:3072 sc1
    buffer_load_dwordx4 v[112:115], v2, s[16:19], s73 offen offset:0 sc1
    buffer_load_dwordx4 v[116:119], v2, s[16:19], s73 offen offset:1024 sc1
    buffer_load_dwordx4 v[120:123], v2, s[16:19], s73 offen offset:2048 sc1
    buffer_load_dwordx4 v[124:127], v2, s[16:19], s73 offen offset:3072 sc1
    v_lshlrev_b32 v8, 16, v32
    v_and_b32 v9, s4, v32
    v_lshlrev_b32 v10, 16, v33
    v_and_b32 v11, s4, v33
    v_lshlrev_b32 v12, 16, v34
    v_and_b32 v13, s4, v34
    v_lshlrev_b32 v14, 16, v35
    v_and_b32 v15, s4, v35
    v_lshlrev_b32 v16, 16, v36
    v_and_b32 v17, s4, v36
    v_lshlrev_b32 v18, 16, v37
    v_and_b32 v19, s4, v37
    v_lshlrev_b32 v20, 16, v38
    v_and_b32 v21, s4, v38
    v_lshlrev_b32 v22, 16, v39
    v_and_b32 v23, s4, v39
    s_movk_i32 s66, 0x2000
    s_waitcnt vmcnt(7)
    v_mfma_f32_32x32x16_bf16 v[32:47], v[96:99], a[224:227], 0
    s_waitcnt vmcnt(6)
    v_mfma_f32_32x32x16_bf16 v[32:47], v[100:103], a[228:231], v[32:47]
    v_max3_u32 v7, v96, v96, v100
    s_waitcnt vmcnt(5)
    v_mfma_f32_32x32x16_bf16 v[48:63], v[104:107], a[232:235], 0
    s_waitcnt vmcnt(4)
    v_mfma_f32_32x32x16_bf16 v[48:63], v[108:111], a[236:239], v[48:63]
    v_max3_u32 v7, v7, v104, v108
    s_waitcnt vmcnt(3)
    v_mfma_f32_32x32x16_bf16 v[64:79], v[112:115], a[240:243], 0
    s_waitcnt vmcnt(2)
    v_mfma_f32_32x32x16_bf16 v[64:79], v[116:119], a[244:247], v[64:79]
    v_max3_u32 v7, v7, v112, v116
    s_waitcnt vmcnt(1)
    v_mfma_f32_32x32x16_bf16 v[80:95], v[120:123], a[248:251], 0
    s_waitcnt vmcnt(0)
    v_mfma_f32_32x32x16_bf16 v[80:95], v[124:127], a[252:255], v[80:95]
    v_max3_u32 v7, v7, v120, v124
    v_cmp_eq_u32 vcc, -1, v7
    s_nop 0
    s_cmp_eq_u64 vcc, 0
    s_cbranch_scc0 L_b_pollr
L_b_gor:
    s_and_b32 s61, s2, 31
    s_lshl2_add_u32 s61, s61, s48
    s_lshr_b32 s62, s61, 3
    s_lshl3_add_u32 s61, s62, s61
    s_mulk_i32 s61, 7168
    v_lshl_add_u32 v252, v1, 7, s61
    v_add_u32 v253, 57344, v252
    s_mov_b32 exec_hi, 0xffffff
    buffer_load_dword v254, v252, s[32:35], 0 offen
    s_mov_b32 exec_hi, -1
    v_add_f32 v96, 0x358637bd, v44
    v_rcp_f32 v96, v96
    v_add_f32 v100, 0x358637bd, v60
    v_rcp_f32 v100, v100
    v_add_f32 v104, 0x358637bd, v76
    v_rcp_f32 v104, v104
    v_add_f32 v108, 0x358637bd, v92
    v_rcp_f32 v108, v108
    v_mov_b32 v98, v96
    v_mov_b32 v102, v100
    v_mov_b32 v106, v104
    v_mov_b32 v110, v108
    v_permlane32_swap_b32 v96, v98
    v_permlane32_swap_b32 v100, v102
    v_permlane32_swap_b32 v104, v106
    v_permlane32_swap_b32 v108, v110
    v_pk_mul_f32 v[32:33], v[32:33], v[98:99] op_sel_hi:[1,0]
    v_pk_mul_f32 v[34:35], v[34:35], v[98:99] op_sel_hi:[1,0]
    v_pk_mul_f32 v[36:37], v[36:37], v[98:99] op_sel_hi:[1,0]
    v_pk_mul_f32 v[38:39], v[38:39], v[98:99] op_sel_hi:[1,0]
    v_pk_mul_f32 v[40:41], v[40:41], v[98:99] op_sel_hi:[1,0]
    v_pk_mul_f32 v[42:43], v[42:43], v[98:99] op_sel_hi:[1,0]
    v_pk_mul_f32 v[44:45], v[44:45], v[98:99] op_sel_hi:[1,0]
    v_pk_mul_f32 v[46:47], v[46:47], v[98:99] op_sel_hi:[1,0]
    v_cvt_pk_bf16_f32 v32, v32, v33
    v_cvt_pk_bf16_f32 v33, v34, v35
    v_cvt_pk_bf16_f32 v34, v36, v37
    v_cvt_pk_bf16_f32 v35, v38, v39
    v_cvt_pk_bf16_f32 v36, v40, v41
    v_cvt_pk_bf16_f32 v37, v42, v43
    v_cvt_pk_bf16_f32 v38, v44, v45
    v_cvt_pk_bf16_f32 v39, v46, v47
    ds_write_b64 v24, v[32:33] offset:0
    ds_write_b64 v24, v[34:35] offset:512
    ds_write_b64 v24, v[36:37] offset:1024
    s_mov_b32 exec_hi, 0
    ds_write_b64 v24, v[38:39] offset:1536
    s_mov_b32 exec_hi, -1
    v_pk_mul_f32 v[48:49], v[48:49], v[102:103] op_sel_hi:[1,0]
    v_pk_mul_f32 v[50:51], v[50:51], v[102:103] op_sel_hi:[1,0]
    v_pk_mul_f32 v[52:53], v[52:53], v[102:103] op_sel_hi:[1,0]
    v_pk_mul_f32 v[54:55], v[54:55], v[102:103] op_sel_hi:[1,0]
    v_pk_mul_f32 v[56:57], v[56:57], v[102:103] op_sel_hi:[1,0]
    v_pk_mul_f32 v[58:59], v[58:59], v[102:103] op_sel_hi:[1,0]
    v_pk_mul_f32 v[60:61], v[60:61], v[102:103] op_sel_hi:[1,0]
    v_pk_mul_f32 v[62:63], v[62:63], v[102:103] op_sel_hi:[1,0]
    v_cvt_pk_bf16_f32 v48, v48, v49
    v_cvt_pk_bf16_f32 v49, v50, v51
    v_cvt_pk_bf16_f32 v50, v52, v53
    v_cvt_pk_bf16_f32 v51, v54, v55
    v_cvt_pk_bf16_f32 v52, v56, v57
    v_cvt_pk_bf16_f32 v53, v58, v59
    v_cvt_pk_bf16_f32 v54, v60, v61
    v_cvt_pk_bf16_f32 v55, v62, v63
    ds_write_b64 v25, v[48:49] offset:1536
    ds_write_b64 v25, v[50:51] offset:2048
    ds_write_b64 v25, v[52:53] offset:2560
    s_mov_b32 exec_hi, 0
    ds_write_b64 v25, v[54:55] offset:3072
    s_mov_b32 exec_hi, -1
    v_pk_mul_f32 v[64:65], v[64:65], v[106:107] op_sel_hi:[1,0]
    v_pk_mul_f32 v[66:67], v[66:67], v[106:107] op_sel_hi:[1,0]
    v_pk_mul_f32 v[68:69], v[68:69], v[106:107] op_sel_hi:[1,0]
    v_pk_mul_f32 v[70:71], v[70:71], v[106:107] op_sel_hi:[1,0]
    v_pk_mul_f32 v[72:73], v[72:73], v[106:107] op_sel_hi:[1,0]
    v_pk_mul_f32 v[74:75], v[74:75], v[106:107] op_sel_hi:[1,0]
    v_pk_mul_f32 v[76:77], v[76:77], v[106:107] op_sel_hi:[1,0]
    v_pk_mul_f32 v[78:79], v[78:79], v[106:107] op_sel_hi:[1,0]
    v_cvt_pk_bf16_f32 v64, v64, v65
    v_cvt_pk_bf16_f32 v65, v66, v67
    v_cvt_pk_bf16_f32 v66, v68, v69
    v_cvt_pk_bf16_f32 v67, v70, v71
    v_cvt_pk_bf16_f32 v68, v72, v73
    v_cvt_pk_bf16_f32 v69, v74, v75
    v_cvt_pk_bf16_f32 v70, v76, v77
    v_cvt_pk_bf16_f32 v71, v78, v79
    ds_write_b64 v24, v[64:65] offset:3584
    ds_write_b64 v24, v[66:67] offset:4096
    ds_write_b64 v24, v[68:69] offset:4608
    s_mov_b32 exec_hi, 0
    ds_write_b64 v24, v[70:71] offset:5120
    s_mov_b32 exec_hi, -1
    v_pk_mul_f32 v[80:81], v[80:81], v[110:111] op_sel_hi:[1,0]
    v_pk_mul_f32 v[82:83], v[82:83], v[110:111] op_sel_hi:[1,0]
    v_pk_mul_f32 v[84:85], v[84:85], v[110:111] op_sel_hi:[1,0]
    v_pk_mul_f32 v[86:87], v[86:87], v[110:111] op_sel_hi:[1,0]
    v_pk_mul_f32 v[88:89], v[88:89], v[110:111] op_sel_hi:[1,0]
    v_pk_mul_f32 v[90:91], v[90:91], v[110:111] op_sel_hi:[1,0]
    v_pk_mul_f32 v[92:93], v[92:93], v[110:111] op_sel_hi:[1,0]
    v_pk_mul_f32 v[94:95], v[94:95], v[110:111] op_sel_hi:[1,0]
    v_cvt_pk_bf16_f32 v80, v80, v81
    v_cvt_pk_bf16_f32 v81, v82, v83
    v_cvt_pk_bf16_f32 v82, v84, v85
    v_cvt_pk_bf16_f32 v83, v86, v87
    v_cvt_pk_bf16_f32 v84, v88, v89
    v_cvt_pk_bf16_f32 v85, v90, v91
    v_cvt_pk_bf16_f32 v86, v92, v93
    v_cvt_pk_bf16_f32 v87, v94, v95
    ds_write_b64 v25, v[80:81] offset:5120
    ds_write_b64 v25, v[82:83] offset:5632
    ds_write_b64 v25, v[84:85] offset:6144
    s_mov_b32 exec_hi, 0
    ds_write_b64 v25, v[86:87] offset:6656
    s_mov_b32 exec_hi, -1
    s_waitcnt lgkmcnt(0)
    s_barrier
    ds_read_b128 v[64:67], v2 offset:0
    ds_read_b128 v[68:71], v2 offset:1024
    ds_read_b128 v[72:75], v2 offset:2048
    ds_read_b128 v[76:79], v2 offset:3072
    ds_read_b128 v[80:83], v2 offset:4096
    s_waitcnt lgkmcnt(4)
    v_mfma_f32_32x32x16_bf16 v[8:23], v[128:131], v[64:67], v[8:23]
    ds_read_b128 v[84:87], v2 offset:5120
    s_waitcnt lgkmcnt(4)
    v_mfma_f32_32x32x16_bf16 v[8:23], v[132:135], v[68:71], v[8:23]
    ds_read_b128 v[64:67], v2 offset:6144
    s_waitcnt lgkmcnt(4)
    v_mfma_f32_32x32x16_bf16 v[8:23], v[136:139], v[72:75], v[8:23]
    ds_read_b128 v[68:71], v2 offset:7168
    s_waitcnt lgkmcnt(4)
    v_mfma_f32_32x32x16_bf16 v[8:23], v[140:143], v[76:79], v[8:23]
    ds_read_b128 v[72:75], v2 offset:8192
    s_waitcnt lgkmcnt(4)
    v_mfma_f32_32x32x16_bf16 v[8:23], v[144:147], v[80:83], v[8:23]
    ds_read_b128 v[76:79], v2 offset:9216
    s_waitcnt lgkmcnt(4)
    v_mfma_f32_32x32x16_bf16 v[8:23], v[148:151], v[84:87], v[8:23]
    ds_read_b128 v[80:83], v2 offset:10240
    s_waitcnt lgkmcnt(4)
    v_mfma_f32_32x32x16_bf16 v[8:23], v[152:155], v[64:67], v[8:23]
    ds_read_b128 v[84:87], v2 offset:11264
    s_waitcnt lgkmcnt(4)
    v_mfma_f32_32x32x16_bf16 v[8:23], v[156:159], v[68:71], v[8:23]
    ds_read_b128 v[64:67], v2 offset:12288
    s_waitcnt lgkmcnt(4)
    v_mfma_f32_32x32x16_bf16 v[8:23], v[160:163], v[72:75], v[8:23]
    ds_read_b128 v[68:71], v2 offset:13312
    s_waitcnt lgkmcnt(4)
    v_mfma_f32_32x32x16_bf16 v[8:23], v[164:167], v[76:79], v[8:23]
    ds_read_b128 v[72:75], v2 offset:14336
    s_waitcnt lgkmcnt(4)
    v_mfma_f32_32x32x16_bf16 v[8:23], v[168:171], v[80:83], v[8:23]
    ds_read_b128 v[76:79], v2 offset:15360
    s_waitcnt lgkmcnt(4)
    v_mfma_f32_32x32x16_bf16 v[8:23], v[172:175], v[84:87], v[8:23]
    ds_read_b128 v[80:83], v2 offset:16384
    s_waitcnt lgkmcnt(4)
    v_mfma_f32_32x32x16_bf16 v[8:23], v[176:179], v[64:67], v[8:23]
    ds_read_b128 v[84:87], v2 offset:17408
    s_waitcnt lgkmcnt(4)
    v_mfma_f32_32x32x16_bf16 v[8:23], v[180:183], v[68:71], v[8:23]
    ds_read_b128 v[64:67], v2 offset:18432
    s_waitcnt lgkmcnt(4)
    v_mfma_f32_32x32x16_bf16 v[8:23], v[184:187], v[72:75], v[8:23]
    ds_read_b128 v[68:71], v2 offset:19456
    s_waitcnt lgkmcnt(4)
    v_mfma_f32_32x32x16_bf16 v[8:23], v[188:191], v[76:79], v[8:23]
    ds_read_b128 v[72:75], v2 offset:20480
    s_waitcnt lgkmcnt(4)
    v_mfma_f32_32x32x16_bf16 v[8:23], v[192:195], v[80:83], v[8:23]
    ds_read_b128 v[76:79], v2 offset:21504
    s_waitcnt lgkmcnt(4)
    v_mfma_f32_32x32x16_bf16 v[8:23], v[196:199], v[84:87], v[8:23]
    ds_read_b128 v[80:83], v2 offset:22528
    s_waitcnt lgkmcnt(4)
    v_mfma_f32_32x32x16_bf16 v[8:23], v[200:203], v[64:67], v[8:23]
    ds_read_b128 v[84:87], v2 offset:23552
    s_waitcnt lgkmcnt(4)
    v_mfma_f32_32x32x16_bf16 v[8:23], v[204:207], v[68:71], v[8:23]
    ds_read_b128 v[64:67], v2 offset:24576
    s_waitcnt lgkmcnt(4)
    v_mfma_f32_32x32x16_bf16 v[8:23], v[208:211], v[72:75], v[8:23]
    ds_read_b128 v[68:71], v2 offset:25600
    s_waitcnt lgkmcnt(4)
    v_mfma_f32_32x32x16_bf16 v[8:23], v[212:215], v[76:79], v[8:23]
    ds_read_b128 v[72:75], v2 offset:26624
    s_waitcnt lgkmcnt(4)
    v_mfma_f32_32x32x16_bf16 v[8:23], v[216:219], v[80:83], v[8:23]
    ds_read_b128 v[76:79], v2 offset:27648
    s_waitcnt lgkmcnt(4)
    v_mfma_f32_32x32x16_bf16 v[8:23], v[220:223], v[84:87], v[8:23]
    s_waitcnt lgkmcnt(3)
    v_mfma_f32_32x32x16_bf16 v[8:23], v[224:227], v[64:67], v[8:23]
    s_waitcnt lgkmcnt(2)
    v_mfma_f32_32x32x16_bf16 v[8:23], v[228:231], v[68:71], v[8:23]
    s_waitcnt lgkmcnt(1)
    v_mfma_f32_32x32x16_bf16 v[8:23], v[232:235], v[72:75], v[8:23]
    v_mov_b32 v40, 0
    v_mov_b32 v41, 0
    s_waitcnt lgkmcnt(0)
    v_mfma_f32_32x32x16_bf16 v[8:23], v[236:239], v[76:79], v[8:23]
    s_nop 11
    v_cvt_pk_bf16_f32 v32, v8, v9
    v_cvt_pk_bf16_f32 v33, v10, v11
    v_cvt_pk_bf16_f32 v34, v12, v13
    v_cvt_pk_bf16_f32 v35, v14, v15
    buffer_store_dwordx4 v[32:35], v2, s[16:19], s58 offen offset:0 sc1
    v_cvt_pk_bf16_f32 v36, v16, v17
    v_cvt_pk_bf16_f32 v37, v18, v19
    v_cvt_pk_bf16_f32 v38, v20, v21
    v_cvt_pk_bf16_f32 v39, v22, v23
    buffer_store_dwordx4 v[36:39], v2, s[16:19], s58 offen offset:1024 sc1
    v_dot2c_f32_bf16 v40, s65, v32
    v_dot2c_f32_bf16 v41, v32, v32
    v_dot2c_f32_bf16 v40, s65, v33
    v_dot2c_f32_bf16 v41, v33, v33
    v_dot2c_f32_bf16 v40, s65, v34
    v_dot2c_f32_bf16 v41, v34, v34
    v_dot2c_f32_bf16 v40, s65, v35
    v_dot2c_f32_bf16 v41, v35, v35
    v_dot2c_f32_bf16 v40, s65, v36
    v_dot2c_f32_bf16 v41, v36, v36
    v_dot2c_f32_bf16 v40, s65, v37
    v_dot2c_f32_bf16 v41, v37, v37
    v_dot2c_f32_bf16 v40, s65, v38
    v_dot2c_f32_bf16 v41, v38, v38
    v_dot2c_f32_bf16 v40, s65, v39
    v_dot2c_f32_bf16 v41, v39, v39
    s_nop 2
    v_permlane32_swap_b32 v40, v41
    v_add_f32 v40, v40, v41
    buffer_store_dword v40, v3, s[16:19], s55 offen sc1
    s_waitcnt vmcnt(0)
    s_mov_b64 exec, 1
    buffer_store_dword v28, off, s[16:19], s7 sc1
    s_mov_b64 exec, -1
    s_mov_b32 exec_hi, 0xffffff
    buffer_load_dword v254, v253, s[32:35], 0 offen
    s_mov_b32 exec_hi, -1
    s_and_b32 s61, s2, 31
    s_cmp_ge_u32 s61, 28
    s_cbranch_scc1 L_cs_done1
    s_bitcmp1_b32 s61, 0
    s_cselect_b32 s44, s28, s24
    s_cselect_b32 s45, s29, s25
    s_mov_b32 s46, s26
    s_mov_b32 s47, 0x20000
    s_lshr_b32 s62, s61, 1
    s_lshl_b32 s62, s62, 8
    s_mul_i32 s63, s48, 401408
    s_add_u32 s62, s62, s63
    v_lshrrev_b32 v4, 3, v1
    v_mul_u32_u24 v4, 3584, v4
    v_and_b32 v5, 7, v1
    v_lshl_add_u32 v4, v5, 4, v4
    buffer_load_dwordx4 v[32:35], v4, s[44:47], s62 offen offset:128
    s_addk_i32 s62, 28672
    buffer_load_dwordx4 v[36:39], v4, s[44:47], s62 offen offset:128
    s_addk_i32 s62, 28672
    buffer_load_dwordx4 v[40:43], v4, s[44:47], s62 offen offset:128
    s_addk_i32 s62, 28672
    buffer_load_dwordx4 v[44:47], v4, s[44:47], s62 offen offset:128
    s_addk_i32 s62, 28672
    buffer_load_dwordx4 v[48:51], v4, s[44:47], s62 offen offset:128
    s_addk_i32 s62, 28672
    buffer_load_dwordx4 v[52:55], v4, s[44:47], s62 offen offset:128
    s_addk_i32 s62, 28672
    buffer_load_dwordx4 v[56:59], v4, s[44:47], s62 offen offset:128
    s_addk_i32 s62, 28672
    buffer_load_dwordx4 v[60:63], v4, s[44:47], s62 offen offset:128
    s_addk_i32 s62, 28672
    buffer_load_dwordx4 v[64:67], v4, s[44:47], s62 offen offset:128
    s_addk_i32 s62, 28672
    buffer_load_dwordx4 v[68:71], v4, s[44:47], s62 offen offset:128
    s_addk_i32 s62, 28672
    buffer_load_dwordx4 v[72:75], v4, s[44:47], s62 offen offset:128
    s_addk_i32 s62, 28672
    buffer_load_dwordx4 v[76:79], v4, s[44:47], s62 offen offset:128
    s_addk_i32 s62, 28672
    buffer_load_dwordx4 v[80:83], v4, s[44:47], s62 offen offset:128
    s_addk_i32 s62, 28672
    buffer_load_dwordx4 v[84:87], v4, s[44:47], s62 offen offset:128
    s_addk_i32 s62, 28672
    s_movk_i32 s70, 0x3f80
    s_mov_b32 s71, 0x3f800000
    s_lshl_b32 s61, s61, 8
    s_add_u32 s61, s61, 1351680
    v_lshrrev_b32 v6, 4, v1
    v_lshlrev_b32 v6, 3, v6
    v_lshl_add_u32 v6, v5, 5, v6
    v_lshl_add_u32 v6, s48, 28, v6
    v_lshlrev_b32 v5, 3, v1
    s_lshl_b32 s63, s48, 9
    v_add_u32 v4, s63, v5
    v_mov_b32 v96, 0
    v_mov_b32 v97, 0
    v_mov_b32 v98, 0
    v_mov_b32 v99, 0
    v_mov_b32 v100, 0
    v_mov_b32 v101, 0
    v_mov_b32 v102, 0
    v_mov_b32 v103, 0
    s_waitcnt vmcnt(13)
    v_dot2c_f32_bf16 v96, s70, v32
    v_dot2c_f32_bf16 v97, s71, v32
    v_dot2c_f32_bf16 v98, s70, v33
    v_dot2c_f32_bf16 v99, s71, v33
    v_dot2c_f32_bf16 v100, s70, v34
    v_dot2c_f32_bf16 v101, s71, v34
    v_dot2c_f32_bf16 v102, s70, v35
    v_dot2c_f32_bf16 v103, s71, v35
    s_waitcnt vmcnt(12)
    v_dot2c_f32_bf16 v96, s70, v36
    v_dot2c_f32_bf16 v97, s71, v36
    v_dot2c_f32_bf16 v98, s70, v37
    v_dot2c_f32_bf16 v99, s71, v37
    v_dot2c_f32_bf16 v100, s70, v38
    v_dot2c_f32_bf16 v101, s71, v38
    v_dot2c_f32_bf16 v102, s70, v39
    v_dot2c_f32_bf16 v103, s71, v39
    s_waitcnt vmcnt(11)
    v_dot2c_f32_bf16 v96, s70, v40
    v_dot2c_f32_bf16 v97, s71, v40
    v_dot2c_f32_bf16 v98, s70, v41
    v_dot2c_f32_bf16 v99, s71, v41
    v_dot2c_f32_bf16 v100, s70, v42
    v_dot2c_f32_bf16 v101, s71, v42
    v_dot2c_f32_bf16 v102, s70, v43
    v_dot2c_f32_bf16 v103, s71, v43
    s_waitcnt vmcnt(10)
    v_dot2c_f32_bf16 v96, s70, v44
    v_dot2c_f32_bf16 v97, s71, v44
    v_dot2c_f32_bf16 v98, s70, v45
    v_dot2c_f32_bf16 v99, s71, v45
    v_dot2c_f32_bf16 v100, s70, v46
    v_dot2c_f32_bf16 v101, s71, v46
    v_dot2c_f32_bf16 v102, s70, v47
    v_dot2c_f32_bf16 v103, s71, v47
    s_waitcnt vmcnt(9)
    v_dot2c_f32_bf16 v96, s70, v48
    v_dot2c_f32_bf16 v97, s71, v48
    v_dot2c_f32_bf16 v98, s70, v49
    v_dot2c_f32_bf16 v99, s71, v49
    v_dot2c_f32_bf16 v100, s70, v50
    v_dot2c_f32_bf16 v101, s71, v50
    v_dot2c_f32_bf16 v102, s70, v51
    v_dot2c_f32_bf16 v103, s71, v51
    s_waitcnt vmcnt(8)
    v_dot2c_f32_bf16 v96, s70, v52
    v_dot2c_f32_bf16 v97, s71, v52
    v_dot2c_f32_bf16 v98, s70, v53
    v_dot2c_f32_bf16 v99, s71, v53
    v_dot2c_f32_bf16 v100, s70, v54
    v_dot2c_f32_bf16 v101, s71, v54
    v_dot2c_f32_bf16 v102, s70, v55
    v_dot2c_f32_bf16 v103, s71, v55
    s_waitcnt vmcnt(7)
    v_dot2c_f32_bf16 v96, s70, v56
    v_dot2c_f32_bf16 v97, s71, v56
    v_dot2c_f32_bf16 v98, s70, v57
    v_dot2c_f32_bf16 v99, s71, v57
    v_dot2c_f32_bf16 v100, s70, v58
    v_dot2c_f32_bf16 v101, s71, v58
    v_dot2c_f32_bf16 v102, s70, v59
    v_dot2c_f32_bf16 v103, s71, v59
    s_waitcnt vmcnt(6)
    v_dot2c_f32_bf16 v96, s70, v60
    v_dot2c_f32_bf16 v97, s71, v60
    v_dot2c_f32_bf16 v98, s70, v61
    v_dot2c_f32_bf16 v99, s71, v61
    v_dot2c_f32_bf16 v100, s70, v62
    v_dot2c_f32_bf16 v101, s71, v62
    v_dot2c_f32_bf16 v102, s70, v63
    v_dot2c_f32_bf16 v103, s71, v63
    s_waitcnt vmcnt(5)
    v_dot2c_f32_bf16 v96, s70, v64
    v_dot2c_f32_bf16 v97, s71, v64
    v_dot2c_f32_bf16 v98, s70, v65
    v_dot2c_f32_bf16 v99, s71, v65
    v_dot2c_f32_bf16 v100, s70, v66
    v_dot2c_f32_bf16 v101, s71, v66
    v_dot2c_f32_bf16 v102, s70, v67
    v_dot2c_f32_bf16 v103, s71, v67
    s_waitcnt vmcnt(4)
    v_dot2c_f32_bf16 v96, s70, v68
    v_dot2c_f32_bf16 v97, s71, v68
    v_dot2c_f32_bf16 v98, s70, v69
    v_dot2c_f32_bf16 v99, s71, v69
    v_dot2c_f32_bf16 v100, s70, v70
    v_dot2c_f32_bf16 v101, s71, v70
    v_dot2c_f32_bf16 v102, s70, v71
    v_dot2c_f32_bf16 v103, s71, v71
    s_waitcnt vmcnt(3)
    v_dot2c_f32_bf16 v96, s70, v72
    v_dot2c_f32_bf16 v97, s71, v72
    v_dot2c_f32_bf16 v98, s70, v73
    v_dot2c_f32_bf16 v99, s71, v73
    v_dot2c_f32_bf16 v100, s70, v74
    v_dot2c_f32_bf16 v101, s71, v74
    v_dot2c_f32_bf16 v102, s70, v75
    v_dot2c_f32_bf16 v103, s71, v75
    s_waitcnt vmcnt(2)
    v_dot2c_f32_bf16 v96, s70, v76
    v_dot2c_f32_bf16 v97, s71, v76
    v_dot2c_f32_bf16 v98, s70, v77
    v_dot2c_f32_bf16 v99, s71, v77
    v_dot2c_f32_bf16 v100, s70, v78
    v_dot2c_f32_bf16 v101, s71, v78
    v_dot2c_f32_bf16 v102, s70, v79
    v_dot2c_f32_bf16 v103, s71, v79
    s_waitcnt vmcnt(1)
    v_dot2c_f32_bf16 v96, s70, v80
    v_dot2c_f32_bf16 v97, s71, v80
    v_dot2c_f32_bf16 v98, s70, v81
    v_dot2c_f32_bf16 v99, s71, v81
    v_dot2c_f32_bf16 v100, s70, v82
    v_dot2c_f32_bf16 v101, s71, v82
    v_dot2c_f32_bf16 v102, s70, v83
    v_dot2c_f32_bf16 v103, s71, v83
    s_waitcnt vmcnt(0)
    v_dot2c_f32_bf16 v96, s70, v84
    v_dot2c_f32_bf16 v97, s71, v84
    v_dot2c_f32_bf16 v98, s70, v85
    v_dot2c_f32_bf16 v99, s71, v85
    v_dot2c_f32_bf16 v100, s70, v86
    v_dot2c_f32_bf16 v101, s71, v86
    v_dot2c_f32_bf16 v102, s70, v87
    v_dot2c_f32_bf16 v103, s71, v87
    v_permlane32_swap_b32 v96, v100
    v_permlane32_swap_b32 v97, v101
    v_permlane32_swap_b32 v98, v102
    v_permlane32_swap_b32 v99, v103
    v_add_f32 v96, v96, v100
    v_add_f32 v97, v97, v101
    v_add_f32 v98, v98, v102
    v_add_f32 v99, v99, v103
    s_nop 0
    v_permlane16_swap_b32 v96, v98
    v_permlane16_swap_b32 v97, v99
    v_add_f32 v96, v96, v98
    v_add_f32 v97, v97, v99
    s_nop 0
    v_add_f32_dpp v96, v96, v96 row_ror:8 row_mask:0xf bank_mask:0xf
    v_add_f32_dpp v97, v97, v97 row_ror:8 row_mask:0xf bank_mask:0xf
    ds_write_b64 v4, v[96:97] offset:34816
    s_waitcnt lgkmcnt(0)
    s_barrier
    ds_read_b64 v[32:33], v5 offset:34816
    ds_read_b64 v[34:35], v5 offset:35328
    ds_read_b64 v[36:37], v5 offset:35840
    ds_read_b64 v[38:39], v5 offset:36352
    s_waitcnt lgkmcnt(2)
    v_pk_add_f32 v[32:33], v[32:33], v[34:35]
    s_waitcnt lgkmcnt(0)
    v_pk_add_f32 v[36:37], v[36:37], v[38:39]
    v_pk_add_f32 v[32:33], v[32:33], v[36:37]
    s_mov_b32 exec_lo, 0xff00ff
    s_mov_b32 exec_hi, 0xff00ff
    buffer_store_dwordx2 v[32:33], v6, s[16:19], s61 offen sc1
    s_mov_b64 exec, -1
L_cs_done1:
    s_waitcnt vmcnt(0)
    s_branch L_fin
L_init_no:
    s_movk_i32 s66, 0x4000
L_init_1:
    buffer_load_dword v214, off, s[40:43], 0 sc1
    s_waitcnt vmcnt(0)
    v_cmp_gt_u32 vcc, 32, v214
    s_sub_u32 s66, s66, 1
    s_cbranch_scc1 L_init_ok
    s_cmp_lg_u32 vcc_lo, 0
    s_cbranch_scc1 L_init_1
    s_branch L_init_ok
L_b_poll:
    s_sub_u32 s66, s66, 1
    s_cbranch_scc1 L_b_go
    buffer_load_dwordx4 v[96:99], v2, s[16:19], s72 offen offset:0 sc1
    buffer_load_dwordx4 v[100:103], v2, s[16:19], s72 offen offset:1024 sc1
    buffer_load_dwordx4 v[104:107], v2, s[16:19], s72 offen offset:2048 sc1
    buffer_load_dwordx4 v[108:111], v2, s[16:19], s72 offen offset:3072 sc1
    buffer_load_dwordx4 v[112:115], v2, s[16:19], s73 offen offset:0 sc1
    buffer_load_dwordx4 v[116:119], v2, s[16:19], s73 offen offset:1024 sc1
    buffer_load_dwordx4 v[120:123], v2, s[16:19], s73 offen offset:2048 sc1
    buffer_load_dwordx4 v[124:127], v2, s[16:19], s73 offen offset:3072 sc1
    s_waitcnt vmcnt(0)
    v_mfma_f32_32x32x16_bf16 v[32:47], v[96:99], a[224:227], 0
    v_mfma_f32_32x32x16_bf16 v[32:47], v[100:103], a[228:231], v[32:47]
    v_max3_u32 v7, v96, v96, v100
    v_mfma_f32_32x32x16_bf16 v[48:63], v[104:107], a[232:235], 0
    v_mfma_f32_32x32x16_bf16 v[48:63], v[108:111], a[236:239], v[48:63]
    v_max3_u32 v7, v7, v104, v108
    v_mfma_f32_32x32x16_bf16 v[64:79], v[112:115], a[240:243], 0
    v_mfma_f32_32x32x16_bf16 v[64:79], v[116:119], a[244:247], v[64:79]
    v_max3_u32 v7, v7, v112, v116
    v_mfma_f32_32x32x16_bf16 v[80:95], v[120:123], a[248:251], 0
    v_mfma_f32_32x32x16_bf16 v[80:95], v[124:127], a[252:255], v[80:95]
    v_max3_u32 v7, v7, v120, v124
    v_cmp_eq_u32 vcc, -1, v7
    s_nop 0
    s_cmp_eq_u64 vcc, 0
    s_cbranch_scc0 L_b_poll
    s_nop 3
    s_branch L_b_go
L_fha_no:
    s_mov_b32 exec_lo, 0x3fff
    s_mov_b32 exec_hi, 0x0
    s_movk_i32 s66, 0x4000
L_fha_15:
    buffer_load_dword v7, v4, s[16:19], s63 offen sc1
    s_waitcnt vmcnt(0)
    v_cmp_eq_u32 vcc, -1, v7
    s_sub_u32 s66, s66, 1
    s_cbranch_scc1 L_fhad_16
    s_and_b64 exec, vcc, exec
    s_cbranch_scc1 L_fha_15
L_fhad_16:
    s_mov_b64 exec, -1
    s_branch L_fha_ok
L_cs1_no:
    s_movk_i32 s66, 0x4000
L_cs1_1:
    buffer_load_dword v88, v92, s[16:19], s44 offen sc1
    s_waitcnt vmcnt(0)
    v_cmp_eq_u32 vcc, -1, v88
    s_sub_u32 s66, s66, 1
    s_cbranch_scc1 L_cs1_ok
    s_cmp_lg_u64 vcc, 0
    s_cbranch_scc1 L_cs1_1
    s_branch L_cs1_ok
L_init_nor:
    s_movk_i32 s66, 0x4000
L_init_1r:
    buffer_load_dword v214, off, s[40:43], 0 sc1
    s_waitcnt vmcnt(0)
    v_cmp_gt_u32 vcc, 32, v214
    s_sub_u32 s66, s66, 1
    s_cbranch_scc1 L_init_okr
    s_cmp_lg_u32 vcc_lo, 0
    s_cbranch_scc1 L_init_1r
    s_branch L_init_okr
L_r_again:
    s_movk_i32 s66, 0x2000
L_r_again1:
    s_mov_b32 s62, s80
    buffer_load_dwordx4 v[32:35], v80, s[16:19], s62 offen sc1
    s_addk_i32 s62, 4096
    buffer_load_dwordx4 v[36:39], v80, s[16:19], s62 offen sc1
    s_addk_i32 s62, 4096
    buffer_load_dwordx4 v[40:43], v80, s[16:19], s62 offen sc1
    s_addk_i32 s62, 4096
    buffer_load_dwordx4 v[44:47], v80, s[16:19], s62 offen sc1
    s_addk_i32 s62, 4096
    buffer_load_dwordx4 v[48:51], v80, s[16:19], s62 offen sc1
    s_addk_i32 s62, 4096
    buffer_load_dwordx4 v[52:55], v80, s[16:19], s62 offen sc1
    s_addk_i32 s62, 4096
    buffer_load_dwordx4 v[56:59], v80, s[16:19], s62 offen sc1
    s_addk_i32 s62, 4096
    buffer_load_dwordx4 v[60:63], v80, s[16:19], s62 offen sc1
    v_mov_b32 v64, 0
    v_mov_b32 v65, 0
    v_mov_b32 v66, 0
    v_mov_b32 v67, 0
    v_mov_b32 v68, 0
    v_mov_b32 v69, 0
    v_mov_b32 v70, 0
    v_mov_b32 v71, 0
    s_waitcnt vmcnt(7)
    v_dot2c_f32_bf16 v64, s46, v32
    v_dot2c_f32_bf16 v65, s47, v32
    v_dot2c_f32_bf16 v66, s46, v33
    v_dot2c_f32_bf16 v67, s47, v33
    v_dot2c_f32_bf16 v68, s46, v34
    v_dot2c_f32_bf16 v69, s47, v34
    v_dot2c_f32_bf16 v70, s46, v35
    v_dot2c_f32_bf16 v71, s47, v35
    s_waitcnt vmcnt(6)
    v_dot2c_f32_bf16 v64, s46, v36
    v_dot2c_f32_bf16 v65, s47, v36
    v_dot2c_f32_bf16 v66, s46, v37
    v_dot2c_f32_bf16 v67, s47, v37
    v_dot2c_f32_bf16 v68, s46, v38
    v_dot2c_f32_bf16 v69, s47, v38
    v_dot2c_f32_bf16 v70, s46, v39
    v_dot2c_f32_bf16 v71, s47, v39
    v_max3_u32 v7, v32, v32, v36
    s_waitcnt vmcnt(5)
    v_dot2c_f32_bf16 v64, s46, v40
    v_dot2c_f32_bf16 v65, s47, v40
    v_dot2c_f32_bf16 v66, s46, v41
    v_dot2c_f32_bf16 v67, s47, v41
    v_dot2c_f32_bf16 v68, s46, v42
    v_dot2c_f32_bf16 v69, s47, v42
    v_dot2c_f32_bf16 v70, s46, v43
    v_dot2c_f32_bf16 v71, s47, v43
    s_waitcnt vmcnt(4)
    v_dot2c_f32_bf16 v64, s46, v44
    v_dot2c_f32_bf16 v65, s47, v44
    v_dot2c_f32_bf16 v66, s46, v45
    v_dot2c_f32_bf16 v67, s47, v45
    v_dot2c_f32_bf16 v68, s46, v46
    v_dot2c_f32_bf16 v69, s47, v46
    v_dot2c_f32_bf16 v70, s46, v47
    v_dot2c_f32_bf16 v71, s47, v47
    v_max3_u32 v7, v7, v40, v44
    s_waitcnt vmcnt(3)
    v_dot2c_f32_bf16 v64, s46, v48
    v_dot2c_f32_bf16 v65, s47, v48
    v_dot2c_f32_bf16 v66, s46, v49
    v_dot2c_f32_bf16 v67, s47, v49
    v_dot2c_f32_bf16 v68, s46, v50
    v_dot2c_f32_bf16 v69, s47, v50
    v_dot2c_f32_bf16 v70, s46, v51
    v_dot2c_f32_bf16 v71, s47, v51
    s_waitcnt vmcnt(2)
    v_dot2c_f32_bf16 v64, s46, v52
    v_dot2c_f32_bf16 v65, s47, v52
    v_dot2c_f32_bf16 v66, s46, v53
    v_dot2c_f32_bf16 v67, s47, v53
    v_dot2c_f32_bf16 v68, s46, v54
    v_dot2c_f32_bf16 v69, s47, v54
    v_dot2c_f32_bf16 v70, s46, v55
    v_dot2c_f32_bf16 v71, s47, v55
    v_max3_u32 v7, v7, v48, v52
    s_waitcnt vmcnt(1)
    v_dot2c_f32_bf16 v64, s46, v56
    v_dot2c_f32_bf16 v65, s47, v56
    v_dot2c_f32_bf16 v66, s46, v57
    v_dot2c_f32_bf16 v67, s47, v57
    v_dot2c_f32_bf16 v68, s46, v58
    v_dot2c_f32_bf16 v69, s47, v58
    v_dot2c_f32_bf16 v70, s46, v59
    v_dot2c_f32_bf16 v71, s47, v59
    s_waitcnt vmcnt(0)
    v_dot2c_f32_bf16 v64, s46, v60
    v_dot2c_f32_bf16 v65, s47, v60
    v_dot2c_f32_bf16 v66, s46, v61
    v_dot2c_f32_bf16 v67, s47, v61
    v_dot2c_f32_bf16 v68, s46, v62
    v_dot2c_f32_bf16 v69, s47, v62
    v_dot2c_f32_bf16 v70, s46, v63
    v_dot2c_f32_bf16 v71, s47, v63
    v_max3_u32 v7, v7, v56, v60
    v_cmp_eq_u32 vcc, -1, v7
    s_sub_u32 s66, s66, 1
    s_cbranch_scc1 L_r_go
    s_cmp_lg_u64 vcc, 0
    s_cbranch_scc1 L_r_again1
    s_branch L_r_go
L_b_pollr:
    s_sub_u32 s66, s66, 1
    s_cbranch_scc1 L_b_gor
    buffer_load_dwordx4 v[96:99], v2, s[16:19], s72 offen offset:0 sc1
    buffer_load_dwordx4 v[100:103], v2, s[16:19], s72 offen offset:1024 sc1
    buffer_load_dwordx4 v[104:107], v2, s[16:19], s72 offen offset:2048 sc1
    buffer_load_dwordx4 v[108:111], v2, s[16:19], s72 offen offset:3072 sc1
    buffer_load_dwordx4 v[112:115], v2, s[16:19], s73 offen offset:0 sc1
    buffer_load_dwordx4 v[116:119], v2, s[16:19], s73 offen offset:1024 sc1
    buffer_load_dwordx4 v[120:123], v2, s[16:19], s73 offen offset:2048 sc1
    buffer_load_dwordx4 v[124:127], v2, s[16:19], s73 offen offset:3072 sc1
    s_waitcnt vmcnt(0)
    v_mfma_f32_32x32x16_bf16 v[32:47], v[96:99], a[224:227], 0
    v_mfma_f32_32x32x16_bf16 v[32:47], v[100:103], a[228:231], v[32:47]
    v_max3_u32 v7, v96, v96, v100
    v_mfma_f32_32x32x16_bf16 v[48:63], v[104:107], a[232:235], 0
    v_mfma_f32_32x32x16_bf16 v[48:63], v[108:111], a[236:239], v[48:63]
    v_max3_u32 v7, v7, v104, v108
    v_mfma_f32_32x32x16_bf16 v[64:79], v[112:115], a[240:243], 0
    v_mfma_f32_32x32x16_bf16 v[64:79], v[116:119], a[244:247], v[64:79]
    v_max3_u32 v7, v7, v112, v116
    v_mfma_f32_32x32x16_bf16 v[80:95], v[120:123], a[248:251], 0
    v_mfma_f32_32x32x16_bf16 v[80:95], v[124:127], a[252:255], v[80:95]
    v_max3_u32 v7, v7, v120, v124
    v_cmp_eq_u32 vcc, -1, v7
    s_nop 0
    s_cmp_eq_u64 vcc, 0
    s_cbranch_scc0 L_b_pollr
    s_nop 3
    s_branch L_b_gor
L_fin:
L_end:
    s_endpgm
    .fill 64, 4, 0xbf800000
.section .rodata,"a"
.p2align 6
.amdhsa_kernel sequential_preLN__linear_attn_block__glu_gated_geglu__prompt_kernel
  .amdhsa_next_free_vgpr 512
  .amdhsa_next_free_sgpr 102
  .amdhsa_accum_offset 256
  .amdhsa_group_segment_fixed_size 0
  .amdhsa_kernarg_size 80
  .amdhsa_user_sgpr_count 2
  .amdhsa_user_sgpr_kernarg_segment_ptr 1
  .amdhsa_system_sgpr_workgroup_id_x 1
  .amdhsa_float_denorm_mode_32 3
.end_amdhsa_kernel
```
